```python
import torch

def _softmax(x, axis=-1):
    return torch.softmax(x, dim=axis)

def _gelu(x):
    return torch.nn.functional.gelu(x, approximate='tanh')

def _silu(x):
    return torch.nn.functional.silu(x)

def _sigmoid(x):
    return torch.sigmoid(x)

def _layernorm(x, axis=-1, eps=1e-05):
    m = x.mean(dim=axis, keepdim=True)
    v = x.var(dim=axis, keepdim=True, unbiased=False)
    return (x - m) / torch.sqrt(v + eps)

def _scatter_add(tgt, idx, src, axis=0):
    return tgt.clone().index_add_(axis, idx, src)

def _segment_sum(src, seg, n):
    out = torch.zeros((n,) + src.shape[1:], dtype=src.dtype)
    return out.index_add_(0, seg, src)

def _pad(x, pw):
    flat = tuple((v for pair in reversed(pw) for v in pair))
    return torch.nn.functional.pad(x, flat)
kernel_name = 'gather_scatter__molecular_angular_painn__graph'

def setup_inputs():

    _w = lambda a: (lambda t: t.to(torch.bfloat16) if t.is_floating_point() else t)(torch.as_tensor(a))
    N, deg, D = (50000, 16, 64)
    n_rbf = max(0, 4)
    E = N * deg
    cutoff = 5.0
    freqs = (torch.arange(1, n_rbf + 1) * torch.pi / cutoff).to(float)
    return {'sv': _w((lambda *s: torch.randn(*s, dtype=torch.bfloat16) * 0.4)(N, 4, D) * 0.3), 'pos': _w((lambda *s: torch.randn(*s, dtype=torch.bfloat16) * 3.2)(N, 3) * 1.2), 'src': _w((lambda lo, hi, *s: torch.randint(lo, hi, s))(0, N, E).to(torch.int64)), 'dst': _w((lambda lo, hi, *s: torch.randint(lo, hi, s))(0, N, E).to(torch.int64)), 'freqs': _w(freqs), 'w_phi1': _w((lambda *s: torch.randn(*s, dtype=torch.bfloat16) * 3.2)(D, D) / D ** 0.5), 'w_phi2': _w((lambda *s: torch.randn(*s, dtype=torch.bfloat16) * 3.2)(D, 3 * D) / D ** 0.5), 'w_rbf': _w((lambda *s: torch.randn(*s, dtype=torch.bfloat16) * 3.2)(n_rbf, 3 * D) / n_rbf ** 0.5)}

def reference(sv, pos, src, dst, freqs, w_phi1, w_phi2, w_rbf):
    N, _, D = sv.shape
    E = src.shape[0]
    PI, cutoff = (3.141592653589793, 5.0)
    s, v = (sv[:, 0, :].clone(), sv[:, 1:, :].clone())
    r_vec = pos[src] - pos[dst]
    d = torch.sqrt((r_vec * r_vec).sum(-1) + 1e-08)
    r_hat = r_vec / d[:, None]
    rbf = torch.sin(d[:, None] * freqs[None, :]) / d[:, None]
    fcut = 0.5 * (torch.cos(PI * d / cutoff) + 1.0)
    fcut = torch.where(d < cutoff, fcut, 0.0 * d)
    Wf = rbf @ w_rbf * fcut[:, None]
    phi = (_silu(s @ w_phi1) @ w_phi2)[src]
    m = phi * Wf
    m_s, m_vv, m_vr = (m[:, :D].clone(), m[:, D:2 * D].clone(), m[:, 2 * D:].clone())
    ds = _segment_sum(m_s, dst, N)
    dv_e = m_vv[:, None, :] * v[src] + m_vr[:, None, :] * r_hat[:, :, None]
    dv = _segment_sum(dv_e.reshape(E, 3 * D), dst, N).reshape(N, 3, D)
    return sv + torch.concatenate([ds[:, None, :], dv], axis=1)
```

```asm
; @launch grid=(256,1,1) block=(512,1,1) lds=163584
.amdgcn_target "amdgcn-amd-amdhsa--gfx950"
.text
.globl gather_scatter__molecular_angular_painn__graph_kernel
.p2align 8
.type gather_scatter__molecular_angular_painn__graph_kernel,@function
gather_scatter__molecular_angular_painn__graph_kernel:
    s_cmp_ge_u32 s2, 256
    s_cbranch_scc1 F_end
    s_load_dwordx2 s[12:13], s[0:1], 8
    s_load_dwordx2 s[84:85], s[0:1], 40
    s_load_dwordx2 s[76:77], s[0:1], 16
    s_load_dwordx2 s[80:81], s[0:1], 24
    s_load_dwordx2 s[8:9], s[0:1], 0
    s_load_dwordx2 s[16:17], s[0:1], 80
    s_load_dwordx2 s[88:89], s[0:1], 48
    s_load_dwordx2 s[92:93], s[0:1], 56
    s_load_dwordx2 s[20:21], s[0:1], 64
    s_load_dwordx2 s[52:53], s[0:1], 32
    v_lshrrev_b32 v1, 6, v0
    v_and_b32 v247, 63, v0
    v_readfirstlane_b32 s25, v1
    v_and_b32 v248, 31, v0
    v_and_b32 v249, 32, v0
    v_lshrrev_b32 v249, 1, v249
    v_lshlrev_b32 v248, 2, v248
    v_lshlrev_b32 v247, 4, v247
    s_mov_b32 s14, 300000
    s_mov_b32 s15, 0x20000
    s_mov_b32 s86, 8192
    s_mov_b32 s87, 0x20000
    s_mov_b32 s78, 3200000
    s_mov_b32 s79, 0x20000
    s_mov_b32 s82, 3200000
    s_mov_b32 s83, 0x20000
    s_mov_b32 s10, 25600000
    s_mov_b32 s11, 0x20000
    s_mov_b32 s18, 11717888
    s_mov_b32 s19, 0x20000
    s_mov_b32 s90, 24576
    s_mov_b32 s91, 0x20000
    s_mov_b32 s94, 1536
    s_mov_b32 s95, 0x20000
    s_mov_b32 s22, 25600000
    s_mov_b32 s23, 0x20000
    s_and_b32 s74, s2, 7
    s_lshl_b32 s24, s74, 5
    s_lshr_b32 s74, s2, 3
    s_add_u32 s24, s24, s74
    s_mul_i32 s41, s24, 196
    s_mul_i32 s26, s25, 49
    s_add_u32 s26, s26, 1
    s_lshr_b32 s26, s26, 1
    s_add_u32 s26, s26, s41
    s_lshl_b32 s34, s26, 9
    s_add_u32 s35, s34, 4096
    s_add_u32 s36, s34, 8192
    s_add_u32 s37, s34, 12288
    s_mov_b32 s42, -1
    s_mov_b32 s43, 0
    s_mul_i32 s27, s25, 12288
    s_add_u32 s27, s27, 44160
    s_mul_i32 s29, s25, 1664
    s_add_u32 s29, s29, 30720
    s_mov_b32 s33, 0xffff0000
    s_mov_b32 s32, 0
    s_mov_b32 s6, 25603072
    s_mov_b32 s7, 0x20000
    v_lshl_add_u32 v246, v249, 7, v248
    s_and_b32 s49, s2, 127
    s_mul_i32 s30, s49, 6250
    s_mul_i32 s69, s25, 3125
    s_lshr_b32 s69, s69, 2
    s_add_u32 s30, s30, s69
    s_lshl_b32 s30, s30, 2
    s_mul_i32 s70, s25, 38912
    s_lshr_b32 s74, s49, 3
    s_lshl_b32 s71, s74, 11
    s_add_u32 s71, s71, s70
    s_add_u32 s75, s70, 38912
    s_lshr_b32 s74, s71, 1
    s_waitcnt lgkmcnt(0)
    s_bitcmp1_b32 s2, 7
    s_cbranch_scc1 F_streamer
    buffer_load_dwordx4 v[0:3], v247, s[12:15], s71 offen
    buffer_load_dwordx4 v[4:7], v247, s[12:15], s71 offen offset:1024
    s_add_u32 s71, s71, 2048
    s_cmp_eq_u32 s71, s75
    s_cselect_b32 s71, s70, s71
    s_load_dword s48, s[16:17], 0
    s_load_dwordx2 s[96:97], s[52:53], 0
    s_sub_u32 s4, s8, 3072
    s_subb_u32 s5, s9, 0
    s_lshl_b32 s68, s25, 6
    v_lshrrev_b32 v245, 4, v247
    v_add_u32 v245, s68, v245
    v_lshlrev_b32 v208, 4, v245
    v_add_u32 v208, 150016, v208
    v_mov_b32 v204, -1
    v_mov_b32 v205, -1
    v_mov_b32 v206, -1
    v_mov_b32 v207, -1
    ds_write_b128 v208, v[204:207]
    s_cmp_lt_u32 s25, 4
    s_cselect_b64 exec, -1, 0
    ds_write_b128 v208, v[204:207] offset:8192
    s_cmp_lt_u32 s25, 5
    s_cselect_b64 exec, -1, 0
    v_lshlrev_b32 v245, 2, v245
    v_add_u32 v245, 162304, v245
    v_mov_b32 v204, 0
    ds_write_b32 v245, v204
    s_mov_b64 exec, -1
    buffer_load_dwordx4 v[8:11], v247, s[12:15], s71 offen
    buffer_load_dwordx4 v[12:15], v247, s[12:15], s71 offen offset:1024
    s_add_u32 s71, s71, 2048
    s_cmp_eq_u32 s71, s75
    s_cselect_b32 s71, s70, s71
    v_lshrrev_b32 v204, 2, v248
    v_lshrrev_b32 v205, 1, v249
    v_sub_u32 v204, v204, v205
    v_mov_b32 v205, 0x4120
    v_mov_b32 v206, 0x41200000
    v_cmp_eq_u32 vcc, 0, v204
    v_cmp_eq_u32 s[52:53], 1, v204
    s_nop 0
    v_cndmask_b32 v196, 0, v205, vcc
    v_cndmask_b32 v196, v196, v206, s[52:53]
    v_cmp_eq_u32 vcc, 2, v204
    v_cmp_eq_u32 s[52:53], 3, v204
    s_nop 0
    v_cndmask_b32 v197, 0, v205, vcc
    v_cndmask_b32 v197, v197, v206, s[52:53]
    v_cmp_eq_u32 vcc, 4, v204
    v_cmp_eq_u32 s[52:53], 5, v204
    s_nop 0
    v_cndmask_b32 v198, 0, v205, vcc
    v_cndmask_b32 v198, v198, v206, s[52:53]
    v_cmp_eq_u32 vcc, 6, v204
    v_cmp_eq_u32 s[52:53], 7, v204
    s_nop 0
    v_cndmask_b32 v199, 0, v205, vcc
    v_cndmask_b32 v199, v199, v206, s[52:53]
    v_cmp_eq_u32 vcc, 16, v204
    v_cmp_eq_u32 s[52:53], 17, v204
    s_nop 0
    v_cndmask_b32 v200, 0, v205, vcc
    v_cndmask_b32 v200, v200, v206, s[52:53]
    v_cmp_eq_u32 vcc, 18, v204
    v_cmp_eq_u32 s[52:53], 19, v204
    s_nop 0
    v_cndmask_b32 v201, 0, v205, vcc
    v_cndmask_b32 v201, v201, v206, s[52:53]
    v_cmp_eq_u32 vcc, 20, v204
    v_cmp_eq_u32 s[52:53], 21, v204
    s_nop 0
    v_cndmask_b32 v202, 0, v205, vcc
    v_cndmask_b32 v202, v202, v206, s[52:53]
    v_cmp_eq_u32 vcc, 22, v204
    v_cmp_eq_u32 s[52:53], 23, v204
    s_nop 0
    v_cndmask_b32 v203, 0, v205, vcc
    v_cndmask_b32 v203, v203, v206, s[52:53]
    buffer_load_dwordx4 v[32:35], v247, s[12:15], s71 offen
    buffer_load_dwordx4 v[36:39], v247, s[12:15], s71 offen offset:1024
    s_add_u32 s71, s71, 2048
    s_cmp_eq_u32 s71, s75
    s_cselect_b32 s71, s70, s71
    buffer_load_dwordx4 v[40:43], v247, s[12:15], s71 offen
    buffer_load_dwordx4 v[44:47], v247, s[12:15], s71 offen offset:1024
    s_add_u32 s71, s71, 2048
    s_cmp_eq_u32 s71, s75
    s_cselect_b32 s71, s70, s71
    s_movk_i32 s38, 128
    s_movk_i32 s39, 3200
    s_movk_i32 s40, 512
    v_mul_u32_u24 v255, 8, v249
    v_add3_u32 v255, v255, v248, s27
    v_lshrrev_b32 v170, 1, v248
    v_and_b32 v171, 0x26, v170
    v_and_b32 v172, 8, v170
    v_lshl_or_b32 v171, v172, 1, v171
    v_and_b32 v172, 16, v170
    v_lshrrev_b32 v172, 1, v172
    v_or_b32 v210, v171, v172
    v_lshlrev_b32 v210, 24, v210
    v_and_b32 v170, 0x30, v248
    v_xor_b32 v170, v249, v170
    v_lshl_add_u32 v170, v248, 4, v170
    v_add_u32 v211, s29, v170
    v_xor_b32 v250, 32, v211
    v_mov_b32 v243, 0
    v_xor_b32 v244, 4, v248
    v_lshrrev_b32 v170, 2, v249
    v_lshl_add_u32 v244, v244, 1, v170
    v_and_b32 v243, 0x70, v247
    v_lshrrev_b32 v212, 3, v247
    v_and_b32 v212, 0x70, v212
    v_and_b32 v210, 0xffffff, v210
    v_lshl_or_b32 v210, v212, 24, v210
    v_lshrrev_b32 v212, 2, v247
    v_and_b32 v212, 64, v212
    v_xor_b32 v245, v212, v247
    v_add_u32 v245, s27, v245
    v_and_b32 v212, 12, v248
    v_lshlrev_b32 v213, 2, v212
    v_lshlrev_b32 v212, 8, v212
    v_and_b32 v214, 0x70, v248
    v_lshl_add_u32 v212, v214, 3, v212
    v_lshlrev_b32 v214, 1, v248
    v_and_b32 v214, 64, v214
    v_or_b32 v213, v213, v214
    v_xor_b32 v213, v249, v213
    v_add3_u32 v212, v212, v213, s27
    v_xor_b32 v213, 32, v212
    v_xor_b32 v214, 64, v212
    v_xor_b32 v215, 0x60, v212
    v_mov_b32 v180, 0x4b400000
    v_mov_b32 v181, v180
    v_mov_b64 v[182:183], v[180:181]
    v_mov_b64 v[184:185], v[180:181]
    v_mov_b64 v[186:187], v[180:181]
    v_mov_b64 v[188:189], v[180:181]
    v_mov_b64 v[190:191], v[180:181]
    v_mov_b64 v[192:193], v[180:181]
    v_mov_b64 v[194:195], v[180:181]
    v_lshrrev_b32 v209, 2, v249
    v_lshl_add_u32 v209, v248, 1, v209
    s_waitcnt lgkmcnt(0)
    s_add_u32 s48, s48, 1
    s_lshr_b32 s68, s48, 8
    s_xor_b32 s68, s68, s48
    s_and_b32 s68, s68, 0xff
    s_cselect_b32 s68, 0, 0x8000
    s_xor_b32 s51, s48, s68
    s_lshl_b32 s44, s51, 24
    s_lshl_b32 s45, s51, 16
    s_and_b32 s45, s45, 0xff000000
    s_lshl_b32 s46, s51, 8
    s_and_b32 s46, s46, 0xff000000
    s_and_b32 s47, s51, 0xff000000
    s_mov_b32 s72, 0x0c0c0400
    s_mov_b32 s73, 0x05040100
    s_lshr_b32 s52, s70, 1
    s_lshr_b32 s53, s75, 1
    s_mov_b32 s32, 85599
    s_movk_i32 s31, -196
    s_waitcnt vmcnt(6)
    v_mfma_f32_32x32x16_bf16 v[148:163], v[196:199], v[0:3], v[180:195]
    v_mfma_f32_32x32x16_bf16 v[148:163], v[200:203], v[4:7], v[148:163]
    buffer_load_dwordx4 v[0:3], v247, s[12:15], s71 offen
    buffer_load_dwordx4 v[4:7], v247, s[12:15], s71 offen offset:1024
    s_add_u32 s71, s71, 2048
    s_cmp_eq_u32 s71, s75
    s_cselect_b32 s71, s70, s71
    s_waitcnt vmcnt(6)
    v_mfma_f32_32x32x16_bf16 v[164:179], v[196:199], v[8:11], v[180:195]
    v_mfma_f32_32x32x16_bf16 v[164:179], v[200:203], v[12:15], v[164:179]
    buffer_load_dwordx4 v[8:11], v247, s[12:15], s71 offen
    buffer_load_dwordx4 v[12:15], v247, s[12:15], s71 offen offset:1024
    s_add_u32 s71, s71, 2048
    s_cmp_eq_u32 s71, s75
    s_cselect_b32 s71, s70, s71
    v_add_u32 v208, s74, v209
    s_cmp_lt_u32 s74, 150016
    s_cselect_b64 vcc, -1, 0
    s_cmp_lt_u32 s74, 149504
    s_cselect_b64 s[54:55], -1, 0
    s_add_u32 s74, s74, 1024
    s_cmp_eq_u32 s74, s53
    s_cselect_b32 s74, s52, s74
    v_perm_b32 v148, v149, v148, s72
    v_perm_b32 v150, v151, v150, s72
    v_perm_b32 v152, v153, v152, s72
    v_perm_b32 v154, v155, v154, s72
    v_perm_b32 v156, v157, v156, s72
    v_perm_b32 v158, v159, v158, s72
    v_perm_b32 v160, v161, v160, s72
    v_perm_b32 v162, v163, v162, s72
    v_perm_b32 v204, v150, v148, s73
    v_perm_b32 v205, v154, v152, s73
    v_perm_b32 v206, v158, v156, s73
    v_perm_b32 v207, v162, v160, s73
    s_mov_b64 exec, vcc
    ds_write2st64_b32 v208, v204, v205 offset0:0 offset1:1
    s_mov_b64 exec, s[54:55]
    ds_write2st64_b32 v208, v206, v207 offset0:2 offset1:3
    s_mov_b64 exec, -1
    s_waitcnt vmcnt(6)
    v_mfma_f32_32x32x16_bf16 v[148:163], v[196:199], v[32:35], v[180:195]
    v_mfma_f32_32x32x16_bf16 v[148:163], v[200:203], v[36:39], v[148:163]
    buffer_load_dwordx4 v[32:35], v247, s[12:15], s71 offen
    buffer_load_dwordx4 v[36:39], v247, s[12:15], s71 offen offset:1024
    s_add_u32 s71, s71, 2048
    s_cmp_eq_u32 s71, s75
    s_cselect_b32 s71, s70, s71
    v_add_u32 v208, s74, v209
    s_cmp_lt_u32 s74, 150016
    s_cselect_b64 vcc, -1, 0
    s_cmp_lt_u32 s74, 149504
    s_cselect_b64 s[54:55], -1, 0
    s_add_u32 s74, s74, 1024
    s_cmp_eq_u32 s74, s53
    s_cselect_b32 s74, s52, s74
    v_perm_b32 v164, v165, v164, s72
    v_perm_b32 v166, v167, v166, s72
    v_perm_b32 v168, v169, v168, s72
    v_perm_b32 v170, v171, v170, s72
    v_perm_b32 v172, v173, v172, s72
    v_perm_b32 v174, v175, v174, s72
    v_perm_b32 v176, v177, v176, s72
    v_perm_b32 v178, v179, v178, s72
    v_perm_b32 v204, v166, v164, s73
    v_perm_b32 v205, v170, v168, s73
    v_perm_b32 v206, v174, v172, s73
    v_perm_b32 v207, v178, v176, s73
    s_mov_b64 exec, vcc
    ds_write2st64_b32 v208, v204, v205 offset0:0 offset1:1
    s_mov_b64 exec, s[54:55]
    ds_write2st64_b32 v208, v206, v207 offset0:2 offset1:3
    s_mov_b64 exec, -1
    s_waitcnt vmcnt(6)
    v_mfma_f32_32x32x16_bf16 v[164:179], v[196:199], v[40:43], v[180:195]
    v_mfma_f32_32x32x16_bf16 v[164:179], v[200:203], v[44:47], v[164:179]
    buffer_load_dwordx4 v[40:43], v247, s[12:15], s71 offen
    buffer_load_dwordx4 v[44:47], v247, s[12:15], s71 offen offset:1024
    s_add_u32 s71, s71, 2048
    s_cmp_eq_u32 s71, s75
    s_cselect_b32 s71, s70, s71
    v_add_u32 v208, s74, v209
    s_cmp_lt_u32 s74, 150016
    s_cselect_b64 vcc, -1, 0
    s_cmp_lt_u32 s74, 149504
    s_cselect_b64 s[54:55], -1, 0
    s_add_u32 s74, s74, 1024
    s_cmp_eq_u32 s74, s53
    s_cselect_b32 s74, s52, s74
    v_perm_b32 v148, v149, v148, s72
    v_perm_b32 v150, v151, v150, s72
    v_perm_b32 v152, v153, v152, s72
    v_perm_b32 v154, v155, v154, s72
    v_perm_b32 v156, v157, v156, s72
    v_perm_b32 v158, v159, v158, s72
    v_perm_b32 v160, v161, v160, s72
    v_perm_b32 v162, v163, v162, s72
    v_perm_b32 v204, v150, v148, s73
    v_perm_b32 v205, v154, v152, s73
    v_perm_b32 v206, v158, v156, s73
    v_perm_b32 v207, v162, v160, s73
    s_mov_b64 exec, vcc
    ds_write2st64_b32 v208, v204, v205 offset0:0 offset1:1
    s_mov_b64 exec, s[54:55]
    ds_write2st64_b32 v208, v206, v207 offset0:2 offset1:3
    s_mov_b64 exec, -1
    s_waitcnt vmcnt(6)
    v_mfma_f32_32x32x16_bf16 v[148:163], v[196:199], v[0:3], v[180:195]
    v_mfma_f32_32x32x16_bf16 v[148:163], v[200:203], v[4:7], v[148:163]
    buffer_load_dwordx4 v[0:3], v247, s[12:15], s71 offen
    buffer_load_dwordx4 v[4:7], v247, s[12:15], s71 offen offset:1024
    s_add_u32 s71, s71, 2048
    s_cmp_eq_u32 s71, s75
    s_cselect_b32 s71, s70, s71
    v_add_u32 v208, s74, v209
    s_cmp_lt_u32 s74, 150016
    s_cselect_b64 vcc, -1, 0
    s_cmp_lt_u32 s74, 149504
    s_cselect_b64 s[54:55], -1, 0
    s_add_u32 s74, s74, 1024
    s_cmp_eq_u32 s74, s53
    s_cselect_b32 s74, s52, s74
    v_perm_b32 v164, v165, v164, s72
    v_perm_b32 v166, v167, v166, s72
    v_perm_b32 v168, v169, v168, s72
    v_perm_b32 v170, v171, v170, s72
    v_perm_b32 v172, v173, v172, s72
    v_perm_b32 v174, v175, v174, s72
    v_perm_b32 v176, v177, v176, s72
    v_perm_b32 v178, v179, v178, s72
    v_perm_b32 v204, v166, v164, s73
    v_perm_b32 v205, v170, v168, s73
    v_perm_b32 v206, v174, v172, s73
    v_perm_b32 v207, v178, v176, s73
    s_mov_b64 exec, vcc
    ds_write2st64_b32 v208, v204, v205 offset0:0 offset1:1
    s_mov_b64 exec, s[54:55]
    ds_write2st64_b32 v208, v206, v207 offset0:2 offset1:3
    s_mov_b64 exec, -1
    s_waitcnt vmcnt(6)
    v_mfma_f32_32x32x16_bf16 v[164:179], v[196:199], v[8:11], v[180:195]
    v_mfma_f32_32x32x16_bf16 v[164:179], v[200:203], v[12:15], v[164:179]
    buffer_load_dwordx4 v[8:11], v247, s[12:15], s71 offen
    buffer_load_dwordx4 v[12:15], v247, s[12:15], s71 offen offset:1024
    s_add_u32 s71, s71, 2048
    s_cmp_eq_u32 s71, s75
    s_cselect_b32 s71, s70, s71
    v_add_u32 v208, s74, v209
    s_cmp_lt_u32 s74, 150016
    s_cselect_b64 vcc, -1, 0
    s_cmp_lt_u32 s74, 149504
    s_cselect_b64 s[54:55], -1, 0
    s_add_u32 s74, s74, 1024
    s_cmp_eq_u32 s74, s53
    s_cselect_b32 s74, s52, s74
    v_perm_b32 v148, v149, v148, s72
    v_perm_b32 v150, v151, v150, s72
    v_perm_b32 v152, v153, v152, s72
    v_perm_b32 v154, v155, v154, s72
    v_perm_b32 v156, v157, v156, s72
    v_perm_b32 v158, v159, v158, s72
    v_perm_b32 v160, v161, v160, s72
    v_perm_b32 v162, v163, v162, s72
    v_perm_b32 v204, v150, v148, s73
    v_perm_b32 v205, v154, v152, s73
    v_perm_b32 v206, v158, v156, s73
    v_perm_b32 v207, v162, v160, s73
    s_mov_b64 exec, vcc
    ds_write2st64_b32 v208, v204, v205 offset0:0 offset1:1
    s_mov_b64 exec, s[54:55]
    ds_write2st64_b32 v208, v206, v207 offset0:2 offset1:3
    s_mov_b64 exec, -1
    s_waitcnt vmcnt(6)
    v_mfma_f32_32x32x16_bf16 v[148:163], v[196:199], v[32:35], v[180:195]
    v_mfma_f32_32x32x16_bf16 v[148:163], v[200:203], v[36:39], v[148:163]
    buffer_load_dwordx4 v[32:35], v247, s[12:15], s71 offen
    buffer_load_dwordx4 v[36:39], v247, s[12:15], s71 offen offset:1024
    s_add_u32 s71, s71, 2048
    s_cmp_eq_u32 s71, s75
    s_cselect_b32 s71, s70, s71
    v_add_u32 v208, s74, v209
    s_cmp_lt_u32 s74, 150016
    s_cselect_b64 vcc, -1, 0
    s_cmp_lt_u32 s74, 149504
    s_cselect_b64 s[54:55], -1, 0
    s_add_u32 s74, s74, 1024
    s_cmp_eq_u32 s74, s53
    s_cselect_b32 s74, s52, s74
    v_perm_b32 v164, v165, v164, s72
    v_perm_b32 v166, v167, v166, s72
    v_perm_b32 v168, v169, v168, s72
    v_perm_b32 v170, v171, v170, s72
    v_perm_b32 v172, v173, v172, s72
    v_perm_b32 v174, v175, v174, s72
    v_perm_b32 v176, v177, v176, s72
    v_perm_b32 v178, v179, v178, s72
    v_perm_b32 v204, v166, v164, s73
    v_perm_b32 v205, v170, v168, s73
    v_perm_b32 v206, v174, v172, s73
    v_perm_b32 v207, v178, v176, s73
    s_mov_b64 exec, vcc
    ds_write2st64_b32 v208, v204, v205 offset0:0 offset1:1
    s_mov_b64 exec, s[54:55]
    ds_write2st64_b32 v208, v206, v207 offset0:2 offset1:3
    s_mov_b64 exec, -1
    s_waitcnt vmcnt(6)
    v_mfma_f32_32x32x16_bf16 v[164:179], v[196:199], v[40:43], v[180:195]
    v_mfma_f32_32x32x16_bf16 v[164:179], v[200:203], v[44:47], v[164:179]
    buffer_load_dwordx4 v[40:43], v247, s[12:15], s71 offen
    buffer_load_dwordx4 v[44:47], v247, s[12:15], s71 offen offset:1024
    s_add_u32 s71, s71, 2048
    s_cmp_eq_u32 s71, s75
    s_cselect_b32 s71, s70, s71
    v_add_u32 v208, s74, v209
    s_cmp_lt_u32 s74, 150016
    s_cselect_b64 vcc, -1, 0
    s_cmp_lt_u32 s74, 149504
    s_cselect_b64 s[54:55], -1, 0
    s_add_u32 s74, s74, 1024
    s_cmp_eq_u32 s74, s53
    s_cselect_b32 s74, s52, s74
    v_perm_b32 v148, v149, v148, s72
    v_perm_b32 v150, v151, v150, s72
    v_perm_b32 v152, v153, v152, s72
    v_perm_b32 v154, v155, v154, s72
    v_perm_b32 v156, v157, v156, s72
    v_perm_b32 v158, v159, v158, s72
    v_perm_b32 v160, v161, v160, s72
    v_perm_b32 v162, v163, v162, s72
    v_perm_b32 v204, v150, v148, s73
    v_perm_b32 v205, v154, v152, s73
    v_perm_b32 v206, v158, v156, s73
    v_perm_b32 v207, v162, v160, s73
    s_mov_b64 exec, vcc
    ds_write2st64_b32 v208, v204, v205 offset0:0 offset1:1
    s_mov_b64 exec, s[54:55]
    ds_write2st64_b32 v208, v206, v207 offset0:2 offset1:3
    s_mov_b64 exec, -1
    s_waitcnt vmcnt(6)
    v_mfma_f32_32x32x16_bf16 v[148:163], v[196:199], v[0:3], v[180:195]
    v_mfma_f32_32x32x16_bf16 v[148:163], v[200:203], v[4:7], v[148:163]
    buffer_load_dwordx4 v[0:3], v247, s[12:15], s71 offen
    buffer_load_dwordx4 v[4:7], v247, s[12:15], s71 offen offset:1024
    s_add_u32 s71, s71, 2048
    s_cmp_eq_u32 s71, s75
    s_cselect_b32 s71, s70, s71
    v_add_u32 v208, s74, v209
    s_cmp_lt_u32 s74, 150016
    s_cselect_b64 vcc, -1, 0
    s_cmp_lt_u32 s74, 149504
    s_cselect_b64 s[54:55], -1, 0
    s_add_u32 s74, s74, 1024
    s_cmp_eq_u32 s74, s53
    s_cselect_b32 s74, s52, s74
    v_perm_b32 v164, v165, v164, s72
    v_perm_b32 v166, v167, v166, s72
    v_perm_b32 v168, v169, v168, s72
    v_perm_b32 v170, v171, v170, s72
    v_perm_b32 v172, v173, v172, s72
    v_perm_b32 v174, v175, v174, s72
    v_perm_b32 v176, v177, v176, s72
    v_perm_b32 v178, v179, v178, s72
    v_perm_b32 v204, v166, v164, s73
    v_perm_b32 v205, v170, v168, s73
    v_perm_b32 v206, v174, v172, s73
    v_perm_b32 v207, v178, v176, s73
    s_mov_b64 exec, vcc
    ds_write2st64_b32 v208, v204, v205 offset0:0 offset1:1
    s_mov_b64 exec, s[54:55]
    ds_write2st64_b32 v208, v206, v207 offset0:2 offset1:3
    s_mov_b64 exec, -1
    s_waitcnt vmcnt(6)
    v_mfma_f32_32x32x16_bf16 v[164:179], v[196:199], v[8:11], v[180:195]
    v_mfma_f32_32x32x16_bf16 v[164:179], v[200:203], v[12:15], v[164:179]
    buffer_load_dwordx4 v[8:11], v247, s[12:15], s71 offen
    buffer_load_dwordx4 v[12:15], v247, s[12:15], s71 offen offset:1024
    s_add_u32 s71, s71, 2048
    s_cmp_eq_u32 s71, s75
    s_cselect_b32 s71, s70, s71
    v_add_u32 v208, s74, v209
    s_cmp_lt_u32 s74, 150016
    s_cselect_b64 vcc, -1, 0
    s_cmp_lt_u32 s74, 149504
    s_cselect_b64 s[54:55], -1, 0
    s_add_u32 s74, s74, 1024
    s_cmp_eq_u32 s74, s53
    s_cselect_b32 s74, s52, s74
    v_perm_b32 v148, v149, v148, s72
    v_perm_b32 v150, v151, v150, s72
    v_perm_b32 v152, v153, v152, s72
    v_perm_b32 v154, v155, v154, s72
    v_perm_b32 v156, v157, v156, s72
    v_perm_b32 v158, v159, v158, s72
    v_perm_b32 v160, v161, v160, s72
    v_perm_b32 v162, v163, v162, s72
    v_perm_b32 v204, v150, v148, s73
    v_perm_b32 v205, v154, v152, s73
    v_perm_b32 v206, v158, v156, s73
    v_perm_b32 v207, v162, v160, s73
    s_mov_b64 exec, vcc
    ds_write2st64_b32 v208, v204, v205 offset0:0 offset1:1
    s_mov_b64 exec, s[54:55]
    ds_write2st64_b32 v208, v206, v207 offset0:2 offset1:3
    s_mov_b64 exec, -1
    s_waitcnt vmcnt(6)
    v_mfma_f32_32x32x16_bf16 v[148:163], v[196:199], v[32:35], v[180:195]
    v_mfma_f32_32x32x16_bf16 v[148:163], v[200:203], v[36:39], v[148:163]
    buffer_load_dwordx4 v[32:35], v247, s[12:15], s71 offen
    buffer_load_dwordx4 v[36:39], v247, s[12:15], s71 offen offset:1024
    s_add_u32 s71, s71, 2048
    s_cmp_eq_u32 s71, s75
    s_cselect_b32 s71, s70, s71
    buffer_load_dwordx4 v[216:219], v247, s[76:79], s30 offen offset:0
    buffer_load_dwordx4 v[230:233], v247, s[80:83], s30 offen offset:0
    buffer_load_dwordx4 v[220:223], v247, s[76:79], s30 offen offset:1024
    buffer_load_dwordx4 v[234:237], v247, s[80:83], s30 offen offset:1024
    buffer_load_dwordx4 v[224:227], v247, s[76:79], s30 offen offset:2048
    buffer_load_dwordx4 v[238:241], v247, s[80:83], s30 offen offset:2048
    buffer_load_dword v228, v248, s[76:79], s30 offen offset:3072
    buffer_load_dword v242, v248, s[80:83], s30 offen offset:3072
    v_add_u32 v208, s74, v209
    s_cmp_lt_u32 s74, 150016
    s_cselect_b64 vcc, -1, 0
    s_cmp_lt_u32 s74, 149504
    s_cselect_b64 s[54:55], -1, 0
    s_add_u32 s74, s74, 1024
    s_cmp_eq_u32 s74, s53
    s_cselect_b32 s74, s52, s74
    v_perm_b32 v164, v165, v164, s72
    v_perm_b32 v166, v167, v166, s72
    v_perm_b32 v168, v169, v168, s72
    v_perm_b32 v170, v171, v170, s72
    v_perm_b32 v172, v173, v172, s72
    v_perm_b32 v174, v175, v174, s72
    v_perm_b32 v176, v177, v176, s72
    v_perm_b32 v178, v179, v178, s72
    v_perm_b32 v204, v166, v164, s73
    v_perm_b32 v205, v170, v168, s73
    v_perm_b32 v206, v174, v172, s73
    v_perm_b32 v207, v178, v176, s73
    s_mov_b64 exec, vcc
    ds_write2st64_b32 v208, v204, v205 offset0:0 offset1:1
    s_mov_b64 exec, s[54:55]
    ds_write2st64_b32 v208, v206, v207 offset0:2 offset1:3
    s_mov_b64 exec, -1
    s_waitcnt vmcnt(14)
    v_mfma_f32_32x32x16_bf16 v[164:179], v[196:199], v[40:43], v[180:195]
    v_mfma_f32_32x32x16_bf16 v[164:179], v[200:203], v[44:47], v[164:179]
    buffer_load_dwordx4 v[40:43], v247, s[12:15], s71 offen
    buffer_load_dwordx4 v[44:47], v247, s[12:15], s71 offen offset:1024
    s_add_u32 s71, s71, 2048
    s_cmp_eq_u32 s71, s75
    s_cselect_b32 s71, s70, s71
    v_add_u32 v208, s74, v209
    s_cmp_lt_u32 s74, 150016
    s_cselect_b64 vcc, -1, 0
    s_cmp_lt_u32 s74, 149504
    s_cselect_b64 s[54:55], -1, 0
    s_add_u32 s74, s74, 1024
    s_cmp_eq_u32 s74, s53
    s_cselect_b32 s74, s52, s74
    v_perm_b32 v148, v149, v148, s72
    v_perm_b32 v150, v151, v150, s72
    v_perm_b32 v152, v153, v152, s72
    v_perm_b32 v154, v155, v154, s72
    v_perm_b32 v156, v157, v156, s72
    v_perm_b32 v158, v159, v158, s72
    v_perm_b32 v160, v161, v160, s72
    v_perm_b32 v162, v163, v162, s72
    v_perm_b32 v204, v150, v148, s73
    v_perm_b32 v205, v154, v152, s73
    v_perm_b32 v206, v158, v156, s73
    v_perm_b32 v207, v162, v160, s73
    s_mov_b64 exec, vcc
    ds_write2st64_b32 v208, v204, v205 offset0:0 offset1:1
    s_mov_b64 exec, s[54:55]
    ds_write2st64_b32 v208, v206, v207 offset0:2 offset1:3
    s_mov_b64 exec, -1
    s_waitcnt vmcnt(14)
    v_mfma_f32_32x32x16_bf16 v[148:163], v[196:199], v[0:3], v[180:195]
    v_mfma_f32_32x32x16_bf16 v[148:163], v[200:203], v[4:7], v[148:163]
    buffer_load_dwordx4 v[0:3], v247, s[12:15], s71 offen
    buffer_load_dwordx4 v[4:7], v247, s[12:15], s71 offen offset:1024
    s_add_u32 s71, s71, 2048
    s_cmp_eq_u32 s71, s75
    s_cselect_b32 s71, s70, s71
    v_add_u32 v208, s74, v209
    s_cmp_lt_u32 s74, 150016
    s_cselect_b64 vcc, -1, 0
    s_cmp_lt_u32 s74, 149504
    s_cselect_b64 s[54:55], -1, 0
    s_add_u32 s74, s74, 1024
    s_cmp_eq_u32 s74, s53
    s_cselect_b32 s74, s52, s74
    v_perm_b32 v164, v165, v164, s72
    v_perm_b32 v166, v167, v166, s72
    v_perm_b32 v168, v169, v168, s72
    v_perm_b32 v170, v171, v170, s72
    v_perm_b32 v172, v173, v172, s72
    v_perm_b32 v174, v175, v174, s72
    v_perm_b32 v176, v177, v176, s72
    v_perm_b32 v178, v179, v178, s72
    v_perm_b32 v204, v166, v164, s73
    v_perm_b32 v205, v170, v168, s73
    v_perm_b32 v206, v174, v172, s73
    v_perm_b32 v207, v178, v176, s73
    s_mov_b64 exec, vcc
    ds_write2st64_b32 v208, v204, v205 offset0:0 offset1:1
    s_mov_b64 exec, s[54:55]
    ds_write2st64_b32 v208, v206, v207 offset0:2 offset1:3
    s_mov_b64 exec, -1
    s_waitcnt vmcnt(14)
    v_mfma_f32_32x32x16_bf16 v[164:179], v[196:199], v[8:11], v[180:195]
    v_mfma_f32_32x32x16_bf16 v[164:179], v[200:203], v[12:15], v[164:179]
    buffer_load_dwordx4 v[8:11], v247, s[12:15], s71 offen
    buffer_load_dwordx4 v[12:15], v247, s[12:15], s71 offen offset:1024
    s_add_u32 s71, s71, 2048
    s_cmp_eq_u32 s71, s75
    s_cselect_b32 s71, s70, s71
    v_add_u32 v208, s74, v209
    s_cmp_lt_u32 s74, 150016
    s_cselect_b64 vcc, -1, 0
    s_cmp_lt_u32 s74, 149504
    s_cselect_b64 s[54:55], -1, 0
    s_add_u32 s74, s74, 1024
    s_cmp_eq_u32 s74, s53
    s_cselect_b32 s74, s52, s74
    v_perm_b32 v148, v149, v148, s72
    v_perm_b32 v150, v151, v150, s72
    v_perm_b32 v152, v153, v152, s72
    v_perm_b32 v154, v155, v154, s72
    v_perm_b32 v156, v157, v156, s72
    v_perm_b32 v158, v159, v158, s72
    v_perm_b32 v160, v161, v160, s72
    v_perm_b32 v162, v163, v162, s72
    v_perm_b32 v204, v150, v148, s73
    v_perm_b32 v205, v154, v152, s73
    v_perm_b32 v206, v158, v156, s73
    v_perm_b32 v207, v162, v160, s73
    s_mov_b64 exec, vcc
    ds_write2st64_b32 v208, v204, v205 offset0:0 offset1:1
    s_mov_b64 exec, s[54:55]
    ds_write2st64_b32 v208, v206, v207 offset0:2 offset1:3
    s_mov_b64 exec, -1
    s_waitcnt vmcnt(14)
    v_mfma_f32_32x32x16_bf16 v[148:163], v[196:199], v[32:35], v[180:195]
    v_mfma_f32_32x32x16_bf16 v[148:163], v[200:203], v[36:39], v[148:163]
    buffer_load_dwordx4 v[32:35], v247, s[12:15], s71 offen
    buffer_load_dwordx4 v[36:39], v247, s[12:15], s71 offen offset:1024
    v_add_u32 v208, s74, v209
    s_cmp_lt_u32 s74, 150016
    s_cselect_b64 vcc, -1, 0
    s_cmp_lt_u32 s74, 149504
    s_cselect_b64 s[54:55], -1, 0
    s_add_u32 s74, s74, 1024
    s_cmp_eq_u32 s74, s53
    s_cselect_b32 s74, s52, s74
    v_perm_b32 v164, v165, v164, s72
    v_perm_b32 v166, v167, v166, s72
    v_perm_b32 v168, v169, v168, s72
    v_perm_b32 v170, v171, v170, s72
    v_perm_b32 v172, v173, v172, s72
    v_perm_b32 v174, v175, v174, s72
    v_perm_b32 v176, v177, v176, s72
    v_perm_b32 v178, v179, v178, s72
    v_perm_b32 v204, v166, v164, s73
    v_perm_b32 v205, v170, v168, s73
    v_perm_b32 v206, v174, v172, s73
    v_perm_b32 v207, v178, v176, s73
    s_mov_b64 exec, vcc
    ds_write2st64_b32 v208, v204, v205 offset0:0 offset1:1
    s_mov_b64 exec, s[54:55]
    ds_write2st64_b32 v208, v206, v207 offset0:2 offset1:3
    s_mov_b64 exec, -1
    s_waitcnt vmcnt(6)
    v_mfma_f32_32x32x16_bf16 v[164:179], v[196:199], v[40:43], v[180:195]
    v_mfma_f32_32x32x16_bf16 v[164:179], v[200:203], v[44:47], v[164:179]
    v_add_u32 v208, s74, v209
    s_cmp_lt_u32 s74, 150016
    s_cselect_b64 vcc, -1, 0
    s_cmp_lt_u32 s74, 149504
    s_cselect_b64 s[54:55], -1, 0
    s_add_u32 s74, s74, 1024
    s_cmp_eq_u32 s74, s53
    s_cselect_b32 s74, s52, s74
    v_perm_b32 v148, v149, v148, s72
    v_perm_b32 v150, v151, v150, s72
    v_perm_b32 v152, v153, v152, s72
    v_perm_b32 v154, v155, v154, s72
    v_perm_b32 v156, v157, v156, s72
    v_perm_b32 v158, v159, v158, s72
    v_perm_b32 v160, v161, v160, s72
    v_perm_b32 v162, v163, v162, s72
    v_perm_b32 v204, v150, v148, s73
    v_perm_b32 v205, v154, v152, s73
    v_perm_b32 v206, v158, v156, s73
    v_perm_b32 v207, v162, v160, s73
    s_mov_b64 exec, vcc
    ds_write2st64_b32 v208, v204, v205 offset0:0 offset1:1
    s_mov_b64 exec, s[54:55]
    ds_write2st64_b32 v208, v206, v207 offset0:2 offset1:3
    s_mov_b64 exec, -1
    s_waitcnt vmcnt(4)
    v_mfma_f32_32x32x16_bf16 v[148:163], v[196:199], v[0:3], v[180:195]
    v_mfma_f32_32x32x16_bf16 v[148:163], v[200:203], v[4:7], v[148:163]
    v_add_u32 v208, s74, v209
    s_cmp_lt_u32 s74, 150016
    s_cselect_b64 vcc, -1, 0
    s_cmp_lt_u32 s74, 149504
    s_cselect_b64 s[54:55], -1, 0
    s_add_u32 s74, s74, 1024
    s_cmp_eq_u32 s74, s53
    s_cselect_b32 s74, s52, s74
    v_lshl_add_u32 v48, v216, 1, v216
    v_lshl_add_u32 v112, v230, 1, v230
    v_and_b32 v80, -4, v48
    v_and_b32 v16, -4, v112
    v_lshl_add_u32 v49, v217, 1, v217
    v_lshl_add_u32 v113, v231, 1, v231
    v_and_b32 v81, -4, v49
    v_and_b32 v17, -4, v113
    v_lshl_add_u32 v50, v218, 1, v218
    v_lshl_add_u32 v114, v232, 1, v232
    v_and_b32 v82, -4, v50
    v_and_b32 v18, -4, v114
    v_lshl_add_u32 v51, v219, 1, v219
    v_perm_b32 v164, v165, v164, s72
    v_perm_b32 v166, v167, v166, s72
    v_perm_b32 v168, v169, v168, s72
    v_perm_b32 v170, v171, v170, s72
    v_perm_b32 v172, v173, v172, s72
    v_perm_b32 v174, v175, v174, s72
    v_perm_b32 v176, v177, v176, s72
    v_perm_b32 v178, v179, v178, s72
    v_perm_b32 v204, v166, v164, s73
    v_perm_b32 v205, v170, v168, s73
    v_perm_b32 v206, v174, v172, s73
    v_perm_b32 v207, v178, v176, s73
    s_mov_b64 exec, vcc
    ds_write2st64_b32 v208, v204, v205 offset0:0 offset1:1
    s_mov_b64 exec, s[54:55]
    ds_write2st64_b32 v208, v206, v207 offset0:2 offset1:3
    s_mov_b64 exec, -1
    s_waitcnt vmcnt(2)
    v_mfma_f32_32x32x16_bf16 v[164:179], v[196:199], v[8:11], v[180:195]
    v_mfma_f32_32x32x16_bf16 v[164:179], v[200:203], v[12:15], v[164:179]
    v_add_u32 v208, s74, v209
    s_cmp_lt_u32 s74, 150016
    s_cselect_b64 vcc, -1, 0
    s_cmp_lt_u32 s74, 149504
    s_cselect_b64 s[54:55], -1, 0
    s_add_u32 s74, s74, 1024
    s_cmp_eq_u32 s74, s53
    s_cselect_b32 s74, s52, s74
    v_lshl_add_u32 v115, v233, 1, v233
    v_and_b32 v83, -4, v51
    v_and_b32 v19, -4, v115
    v_lshl_add_u32 v52, v220, 1, v220
    v_lshl_add_u32 v116, v234, 1, v234
    v_and_b32 v84, -4, v52
    v_and_b32 v20, -4, v116
    v_lshl_add_u32 v53, v221, 1, v221
    v_lshl_add_u32 v117, v235, 1, v235
    v_and_b32 v85, -4, v53
    v_and_b32 v21, -4, v117
    v_lshl_add_u32 v54, v222, 1, v222
    v_lshl_add_u32 v118, v236, 1, v236
    v_perm_b32 v148, v149, v148, s72
    v_perm_b32 v150, v151, v150, s72
    v_perm_b32 v152, v153, v152, s72
    v_perm_b32 v154, v155, v154, s72
    v_perm_b32 v156, v157, v156, s72
    v_perm_b32 v158, v159, v158, s72
    v_perm_b32 v160, v161, v160, s72
    v_perm_b32 v162, v163, v162, s72
    v_perm_b32 v204, v150, v148, s73
    v_perm_b32 v205, v154, v152, s73
    v_perm_b32 v206, v158, v156, s73
    v_perm_b32 v207, v162, v160, s73
    s_mov_b64 exec, vcc
    ds_write2st64_b32 v208, v204, v205 offset0:0 offset1:1
    s_mov_b64 exec, s[54:55]
    ds_write2st64_b32 v208, v206, v207 offset0:2 offset1:3
    s_mov_b64 exec, -1
    s_waitcnt vmcnt(0)
    v_mfma_f32_32x32x16_bf16 v[148:163], v[196:199], v[32:35], v[180:195]
    v_mfma_f32_32x32x16_bf16 v[148:163], v[200:203], v[36:39], v[148:163]
    v_add_u32 v208, s74, v209
    s_cmp_lt_u32 s74, 150016
    s_cselect_b64 vcc, -1, 0
    s_cmp_lt_u32 s74, 149504
    s_cselect_b64 s[54:55], -1, 0
    s_add_u32 s74, s74, 1024
    s_cmp_eq_u32 s74, s53
    s_cselect_b32 s74, s52, s74
    v_and_b32 v86, -4, v54
    v_and_b32 v22, -4, v118
    v_lshl_add_u32 v55, v223, 1, v223
    v_lshl_add_u32 v119, v237, 1, v237
    v_and_b32 v87, -4, v55
    v_and_b32 v23, -4, v119
    v_lshl_add_u32 v56, v224, 1, v224
    v_lshl_add_u32 v120, v238, 1, v238
    v_and_b32 v88, -4, v56
    v_and_b32 v24, -4, v120
    v_lshl_add_u32 v57, v225, 1, v225
    v_lshl_add_u32 v121, v239, 1, v239
    v_and_b32 v89, -4, v57
    v_perm_b32 v164, v165, v164, s72
    v_perm_b32 v166, v167, v166, s72
    v_perm_b32 v168, v169, v168, s72
    v_perm_b32 v170, v171, v170, s72
    v_perm_b32 v172, v173, v172, s72
    v_perm_b32 v174, v175, v174, s72
    v_perm_b32 v176, v177, v176, s72
    v_perm_b32 v178, v179, v178, s72
    v_perm_b32 v204, v166, v164, s73
    v_perm_b32 v205, v170, v168, s73
    v_perm_b32 v206, v174, v172, s73
    v_perm_b32 v207, v178, v176, s73
    s_mov_b64 exec, vcc
    ds_write2st64_b32 v208, v204, v205 offset0:0 offset1:1
    s_mov_b64 exec, s[54:55]
    ds_write2st64_b32 v208, v206, v207 offset0:2 offset1:3
    s_mov_b64 exec, -1
    v_add_u32 v208, s74, v209
    s_cmp_lt_u32 s74, 150016
    s_cselect_b64 vcc, -1, 0
    s_cmp_lt_u32 s74, 149504
    s_cselect_b64 s[54:55], -1, 0
    v_and_b32 v25, -4, v121
    v_lshl_add_u32 v58, v226, 1, v226
    v_lshl_add_u32 v122, v240, 1, v240
    v_and_b32 v90, -4, v58
    v_and_b32 v26, -4, v122
    v_lshl_add_u32 v59, v227, 1, v227
    v_lshl_add_u32 v123, v241, 1, v241
    v_and_b32 v91, -4, v59
    v_and_b32 v27, -4, v123
    v_lshl_add_u32 v60, v228, 1, v228
    v_lshl_add_u32 v124, v242, 1, v242
    v_and_b32 v92, -4, v60
    v_and_b32 v28, -4, v124
    v_perm_b32 v148, v149, v148, s72
    v_perm_b32 v150, v151, v150, s72
    v_perm_b32 v152, v153, v152, s72
    v_perm_b32 v154, v155, v154, s72
    v_perm_b32 v156, v157, v156, s72
    v_perm_b32 v158, v159, v158, s72
    v_perm_b32 v160, v161, v160, s72
    v_perm_b32 v162, v163, v162, s72
    v_perm_b32 v204, v150, v148, s73
    v_perm_b32 v205, v154, v152, s73
    v_perm_b32 v206, v158, v156, s73
    v_perm_b32 v207, v162, v160, s73
    s_mov_b64 exec, vcc
    ds_write2st64_b32 v208, v204, v205 offset0:0 offset1:1
    s_mov_b64 exec, s[54:55]
    ds_write2st64_b32 v208, v206, v207 offset0:2 offset1:3
    s_mov_b64 exec, -1
    v_mov_b32 v176, 1
    s_movk_i32 s70, 2584
    s_mov_b32 s71, 162304
    s_mul_i32 s72, s49, 25000
    s_add_u32 s72, s72, 2117888
    s_mov_b32 s73, 150016
    s_mov_b32 s69, 158208
    s_waitcnt lgkmcnt(0)
    s_barrier
    s_mov_b64 s[74:75], 0
    ds_read2_b32 v[144:145], v80 offset0:0 offset1:1
    ds_read2_b32 v[146:147], v81 offset0:0 offset1:1
    ds_read2_b32 v[148:149], v82 offset0:0 offset1:1
    ds_read2_b32 v[150:151], v83 offset0:0 offset1:1
    ds_read2_b32 v[152:153], v84 offset0:0 offset1:1
    ds_read2_b32 v[154:155], v85 offset0:0 offset1:1
    ds_read2_b32 v[156:157], v86 offset0:0 offset1:1
    ds_read2_b32 v[160:161], v16 offset0:0 offset1:1
    ds_read2_b32 v[162:163], v17 offset0:0 offset1:1
    ds_read2_b32 v[164:165], v18 offset0:0 offset1:1
    ds_read2_b32 v[166:167], v19 offset0:0 offset1:1
    ds_read2_b32 v[168:169], v20 offset0:0 offset1:1
    ds_read2_b32 v[170:171], v21 offset0:0 offset1:1
    ds_read2_b32 v[172:173], v22 offset0:0 offset1:1
    v_mul_u32_u24 v251, 192, v249
    v_add_u32 v251, v251, v248
    s_lshr_b32 s68, s25, 2
    s_lshl_b32 s68, s68, 7
    s_and_b32 s69, s25, 1
    s_mul_i32 s69, s69, 12288
    s_add_u32 s68, s68, s69
    s_bfe_u32 s69, s25, 0x10001
    s_mul_i32 s69, s69, 384
    s_add_u32 s68, s68, s69
    s_add_u32 s69, s68, 6144
    buffer_load_dword v128, v251, s[88:91], s68 offen offset:0
    buffer_load_dword v129, v251, s[88:91], s68 offen offset:768
    buffer_load_dword v130, v251, s[88:91], s68 offen offset:1536
    buffer_load_dword v131, v251, s[88:91], s68 offen offset:2304
    buffer_load_dword v132, v251, s[88:91], s69 offen offset:0
    buffer_load_dword v133, v251, s[88:91], s69 offen offset:768
    buffer_load_dword v134, v251, s[88:91], s69 offen offset:1536
    buffer_load_dword v135, v251, s[88:91], s69 offen offset:2304
    s_add_u32 s70, s25, 8
    s_lshr_b32 s68, s70, 2
    s_lshl_b32 s68, s68, 7
    s_and_b32 s69, s70, 1
    s_mul_i32 s69, s69, 12288
    s_add_u32 s68, s68, s69
    s_bfe_u32 s69, s70, 0x10001
    s_mul_i32 s69, s69, 384
    s_add_u32 s68, s68, s69
    s_cmp_lt_u32 s25, 4
    s_cselect_b32 s68, s68, 0x10000
    s_add_u32 s69, s68, 6144
    buffer_load_dword v136, v251, s[88:91], s68 offen offset:0
    buffer_load_dword v137, v251, s[88:91], s68 offen offset:768
    buffer_load_dword v138, v251, s[88:91], s68 offen offset:1536
    buffer_load_dword v139, v251, s[88:91], s68 offen offset:2304
    buffer_load_dword v140, v251, s[88:91], s69 offen offset:0
    buffer_load_dword v141, v251, s[88:91], s69 offen offset:768
    buffer_load_dword v142, v251, s[88:91], s69 offen offset:1536
    buffer_load_dword v143, v251, s[88:91], s69 offen offset:2304
    v_mul_u32_u24 v251, 48, v249
    v_add_u32 v251, v251, v248
    s_sub_u32 s68, s25, 4
    s_lshl_b32 s68, s68, 7
    s_cmp_lt_u32 s25, 4
    s_cselect_b32 s68, 0x10000, s68
    buffer_load_dword v174, v251, s[92:95], s68 offen
    buffer_load_dword v175, v251, s[92:95], s68 offen offset:384
    s_movk_i32 s70, 2584
    s_mov_b32 s69, 158208
    buffer_load_dword v64, v246, s[8:11], s34 offen offset:256
    buffer_load_dword v96, v246, s[8:11], s34 offen offset:384
    buffer_load_dword v65, v246, s[8:11], s34 offen offset:768
    buffer_load_dword v97, v246, s[8:11], s34 offen offset:896
    buffer_load_dword v66, v246, s[8:11], s34 offen offset:1280
    buffer_load_dword v98, v246, s[8:11], s34 offen offset:1408
    buffer_load_dword v67, v246, s[8:11], s34 offen offset:1792
    v_mul_u32_u24 v180, s32, v230
    v_lshrrev_b32 v180, 24, v180
    v_mad_i32_i24 v194, v180, s31, v230
    v_mul_u32_u24 v181, s32, v231
    v_lshrrev_b32 v181, 24, v181
    v_mad_i32_i24 v195, v181, s31, v231
    v_mul_u32_u24 v182, s32, v232
    v_lshrrev_b32 v182, 24, v182
    v_mad_i32_i24 v196, v182, s31, v232
    v_mul_u32_u24 v183, s32, v233
    v_lshrrev_b32 v183, 24, v183
    v_mad_i32_i24 v197, v183, s31, v233
    v_mul_u32_u24 v184, s32, v234
    v_lshrrev_b32 v184, 24, v184
    v_mad_i32_i24 v198, v184, s31, v234
    v_mul_u32_u24 v185, s32, v235
    v_lshrrev_b32 v185, 24, v185
    v_mad_i32_i24 v199, v185, s31, v235
    v_mul_u32_u24 v186, s32, v236
    v_lshrrev_b32 v186, 24, v186
    v_mad_i32_i24 v200, v186, s31, v236
    v_mul_u32_u24 v187, s32, v237
    v_lshrrev_b32 v187, 24, v187
    v_mad_i32_i24 v201, v187, s31, v237
    v_mul_u32_u24 v188, s32, v238
    v_lshrrev_b32 v188, 24, v188
    v_mad_i32_i24 v202, v188, s31, v238
    v_mul_u32_u24 v189, s32, v239
    v_lshrrev_b32 v189, 24, v189
    v_mad_i32_i24 v203, v189, s31, v239
    v_mul_u32_u24 v190, s32, v240
    v_lshrrev_b32 v190, 24, v190
    v_mad_i32_i24 v204, v190, s31, v240
    v_mul_u32_u24 v191, s32, v241
    v_lshrrev_b32 v191, 24, v191
    v_mad_i32_i24 v205, v191, s31, v241
    v_mul_u32_u24 v192, s32, v242
    v_lshrrev_b32 v192, 24, v192
    v_mad_i32_i24 v206, v192, s31, v242
    buffer_load_dword v99, v246, s[8:11], s34 offen offset:1920
    buffer_load_dword v68, v246, s[8:11], s35 offen offset:256
    buffer_load_dword v100, v246, s[8:11], s35 offen offset:384
    buffer_load_dword v69, v246, s[8:11], s35 offen offset:768
    buffer_load_dword v101, v246, s[8:11], s35 offen offset:896
    buffer_load_dword v70, v246, s[8:11], s35 offen offset:1280
    buffer_load_dword v102, v246, s[8:11], s35 offen offset:1408
    s_waitcnt lgkmcnt(1)
    v_alignbyte_b32 v80, v145, v144, v48
    v_alignbyte_b32 v81, v147, v146, v49
    v_alignbyte_b32 v82, v149, v148, v50
    v_alignbyte_b32 v83, v151, v150, v51
    v_alignbyte_b32 v84, v153, v152, v52
    v_alignbyte_b32 v85, v155, v154, v53
    v_alignbyte_b32 v86, v157, v156, v54
    v_alignbyte_b32 v16, v161, v160, v112
    v_alignbyte_b32 v17, v163, v162, v113
    v_alignbyte_b32 v18, v165, v164, v114
    v_alignbyte_b32 v19, v167, v166, v115
    v_alignbyte_b32 v20, v169, v168, v116
    v_alignbyte_b32 v21, v171, v170, v117
    s_waitcnt lgkmcnt(0)
    v_alignbyte_b32 v22, v173, v172, v118
    ds_read2_b32 v[144:145], v87 offset0:0 offset1:1
    ds_read2_b32 v[146:147], v88 offset0:0 offset1:1
    ds_read2_b32 v[148:149], v89 offset0:0 offset1:1
    ds_read2_b32 v[150:151], v90 offset0:0 offset1:1
    ds_read2_b32 v[152:153], v91 offset0:0 offset1:1
    ds_read2_b32 v[154:155], v92 offset0:0 offset1:1
    ds_read2_b32 v[160:161], v23 offset0:0 offset1:1
    ds_read2_b32 v[162:163], v24 offset0:0 offset1:1
    ds_read2_b32 v[164:165], v25 offset0:0 offset1:1
    ds_read2_b32 v[166:167], v26 offset0:0 offset1:1
    ds_read2_b32 v[168:169], v27 offset0:0 offset1:1
    ds_read2_b32 v[170:171], v28 offset0:0 offset1:1
    buffer_load_dword v71, v246, s[8:11], s35 offen offset:1792
    buffer_load_dword v103, v246, s[8:11], s35 offen offset:1920
    buffer_load_dword v72, v246, s[8:11], s36 offen offset:256
    buffer_load_dword v104, v246, s[8:11], s36 offen offset:384
    buffer_load_dword v73, v246, s[8:11], s36 offen offset:768
    buffer_load_dword v105, v246, s[8:11], s36 offen offset:896
    buffer_load_dword v74, v246, s[8:11], s36 offen offset:1280
    v_sub_u32_sdwa v48, v80, v16 dst_sel:BYTE_0 dst_unused:UNUSED_PAD src0_sel:BYTE_0 src1_sel:BYTE_0
    v_sub_u32_sdwa v49, v81, v17 dst_sel:BYTE_0 dst_unused:UNUSED_PAD src0_sel:BYTE_0 src1_sel:BYTE_0
    v_sub_u32_sdwa v50, v82, v18 dst_sel:BYTE_0 dst_unused:UNUSED_PAD src0_sel:BYTE_0 src1_sel:BYTE_0
    v_sub_u32_sdwa v51, v83, v19 dst_sel:BYTE_0 dst_unused:UNUSED_PAD src0_sel:BYTE_0 src1_sel:BYTE_0
    v_sub_u32_sdwa v52, v84, v20 dst_sel:BYTE_0 dst_unused:UNUSED_PAD src0_sel:BYTE_0 src1_sel:BYTE_0
    v_sub_u32_sdwa v53, v85, v21 dst_sel:BYTE_0 dst_unused:UNUSED_PAD src0_sel:BYTE_0 src1_sel:BYTE_0
    v_sub_u32_sdwa v54, v86, v22 dst_sel:BYTE_0 dst_unused:UNUSED_PAD src0_sel:BYTE_0 src1_sel:BYTE_0
    v_sub_u32_sdwa v48, v80, v16 dst_sel:BYTE_1 dst_unused:UNUSED_PRESERVE src0_sel:BYTE_1 src1_sel:BYTE_1
    v_sub_u32_sdwa v49, v81, v17 dst_sel:BYTE_1 dst_unused:UNUSED_PRESERVE src0_sel:BYTE_1 src1_sel:BYTE_1
    v_sub_u32_sdwa v50, v82, v18 dst_sel:BYTE_1 dst_unused:UNUSED_PRESERVE src0_sel:BYTE_1 src1_sel:BYTE_1
    v_sub_u32_sdwa v51, v83, v19 dst_sel:BYTE_1 dst_unused:UNUSED_PRESERVE src0_sel:BYTE_1 src1_sel:BYTE_1
    v_sub_u32_sdwa v52, v84, v20 dst_sel:BYTE_1 dst_unused:UNUSED_PRESERVE src0_sel:BYTE_1 src1_sel:BYTE_1
    v_sub_u32_sdwa v53, v85, v21 dst_sel:BYTE_1 dst_unused:UNUSED_PRESERVE src0_sel:BYTE_1 src1_sel:BYTE_1
    v_sub_u32_sdwa v54, v86, v22 dst_sel:BYTE_1 dst_unused:UNUSED_PRESERVE src0_sel:BYTE_1 src1_sel:BYTE_1
    v_sub_u32_sdwa v48, v80, v16 dst_sel:BYTE_2 dst_unused:UNUSED_PRESERVE src0_sel:BYTE_2 src1_sel:BYTE_2
    v_sub_u32_sdwa v49, v81, v17 dst_sel:BYTE_2 dst_unused:UNUSED_PRESERVE src0_sel:BYTE_2 src1_sel:BYTE_2
    v_sub_u32_sdwa v50, v82, v18 dst_sel:BYTE_2 dst_unused:UNUSED_PRESERVE src0_sel:BYTE_2 src1_sel:BYTE_2
    v_sub_u32_sdwa v51, v83, v19 dst_sel:BYTE_2 dst_unused:UNUSED_PRESERVE src0_sel:BYTE_2 src1_sel:BYTE_2
    v_sub_u32_sdwa v52, v84, v20 dst_sel:BYTE_2 dst_unused:UNUSED_PRESERVE src0_sel:BYTE_2 src1_sel:BYTE_2
    v_sub_u32_sdwa v53, v85, v21 dst_sel:BYTE_2 dst_unused:UNUSED_PRESERVE src0_sel:BYTE_2 src1_sel:BYTE_2
    v_sub_u32_sdwa v54, v86, v22 dst_sel:BYTE_2 dst_unused:UNUSED_PRESERVE src0_sel:BYTE_2 src1_sel:BYTE_2
    v_dot4_i32_i8 v48, v48, v48, 0
    v_dot4_i32_i8 v49, v49, v49, 0
    v_dot4_i32_i8 v50, v50, v50, 0
    v_dot4_i32_i8 v51, v51, v51, 0
    v_dot4_i32_i8 v52, v52, v52, 0
    v_dot4_i32_i8 v53, v53, v53, 0
    v_dot4_i32_i8 v54, v54, v54, 0
    v_lshl_add_u32 v112, v180, 2, s71
    v_lshl_add_u32 v113, v181, 2, s71
    v_lshl_add_u32 v114, v182, 2, s71
    v_lshl_add_u32 v115, v183, 2, s71
    v_lshl_add_u32 v116, v184, 2, s71
    v_lshl_add_u32 v117, v185, 2, s71
    v_lshl_add_u32 v118, v186, 2, s71
    v_cmp_gt_u32 s[52:53], s70, v48
    v_cmp_gt_u32 s[54:55], s70, v49
    v_cmp_gt_u32 s[56:57], s70, v50
    v_cmp_gt_u32 s[58:59], s70, v51
    v_cmp_gt_u32 s[60:61], s70, v52
    v_cmp_gt_u32 s[62:63], s70, v53
    v_cmp_gt_u32 s[64:65], s70, v54
    s_mov_b64 exec, s[52:53]
    ds_add_rtn_u32 v112, v112, v176
    s_mov_b64 exec, s[54:55]
    ds_add_rtn_u32 v113, v113, v176
    s_mov_b64 exec, s[56:57]
    ds_add_rtn_u32 v114, v114, v176
    s_mov_b64 exec, s[58:59]
    ds_add_rtn_u32 v115, v115, v176
    s_mov_b64 exec, s[60:61]
    ds_add_rtn_u32 v116, v116, v176
    s_mov_b64 exec, s[62:63]
    ds_add_rtn_u32 v117, v117, v176
    s_mov_b64 exec, s[64:65]
    ds_add_rtn_u32 v118, v118, v176
    s_mov_b64 exec, -1
    buffer_load_dword v106, v246, s[8:11], s36 offen offset:1408
    buffer_load_dword v75, v246, s[8:11], s36 offen offset:1792
    buffer_load_dword v107, v246, s[8:11], s36 offen offset:1920
    buffer_load_dword v76, v246, s[8:11], s37 offen offset:256
    buffer_load_dword v108, v246, s[8:11], s37 offen offset:384
    buffer_load_dword v0, v246, s[8:11], s34 offen offset:0
    buffer_load_dword v32, v246, s[8:11], s34 offen offset:128
    s_waitcnt lgkmcnt(7)
    v_alignbyte_b32 v87, v145, v144, v55
    v_alignbyte_b32 v88, v147, v146, v56
    v_alignbyte_b32 v89, v149, v148, v57
    v_alignbyte_b32 v90, v151, v150, v58
    v_alignbyte_b32 v91, v153, v152, v59
    v_alignbyte_b32 v92, v155, v154, v60
    v_alignbyte_b32 v23, v161, v160, v119
    v_alignbyte_b32 v24, v163, v162, v120
    v_alignbyte_b32 v25, v165, v164, v121
    v_alignbyte_b32 v26, v167, v166, v122
    v_alignbyte_b32 v27, v169, v168, v123
    v_alignbyte_b32 v28, v171, v170, v124
    v_sub_u32_sdwa v55, v87, v23 dst_sel:BYTE_0 dst_unused:UNUSED_PAD src0_sel:BYTE_0 src1_sel:BYTE_0
    v_sub_u32_sdwa v56, v88, v24 dst_sel:BYTE_0 dst_unused:UNUSED_PAD src0_sel:BYTE_0 src1_sel:BYTE_0
    v_sub_u32_sdwa v57, v89, v25 dst_sel:BYTE_0 dst_unused:UNUSED_PAD src0_sel:BYTE_0 src1_sel:BYTE_0
    v_sub_u32_sdwa v58, v90, v26 dst_sel:BYTE_0 dst_unused:UNUSED_PAD src0_sel:BYTE_0 src1_sel:BYTE_0
    v_sub_u32_sdwa v59, v91, v27 dst_sel:BYTE_0 dst_unused:UNUSED_PAD src0_sel:BYTE_0 src1_sel:BYTE_0
    v_sub_u32_sdwa v60, v92, v28 dst_sel:BYTE_0 dst_unused:UNUSED_PAD src0_sel:BYTE_0 src1_sel:BYTE_0
    v_sub_u32_sdwa v55, v87, v23 dst_sel:BYTE_1 dst_unused:UNUSED_PRESERVE src0_sel:BYTE_1 src1_sel:BYTE_1
    v_sub_u32_sdwa v56, v88, v24 dst_sel:BYTE_1 dst_unused:UNUSED_PRESERVE src0_sel:BYTE_1 src1_sel:BYTE_1
    v_sub_u32_sdwa v57, v89, v25 dst_sel:BYTE_1 dst_unused:UNUSED_PRESERVE src0_sel:BYTE_1 src1_sel:BYTE_1
    v_sub_u32_sdwa v58, v90, v26 dst_sel:BYTE_1 dst_unused:UNUSED_PRESERVE src0_sel:BYTE_1 src1_sel:BYTE_1
    v_sub_u32_sdwa v59, v91, v27 dst_sel:BYTE_1 dst_unused:UNUSED_PRESERVE src0_sel:BYTE_1 src1_sel:BYTE_1
    v_sub_u32_sdwa v60, v92, v28 dst_sel:BYTE_1 dst_unused:UNUSED_PRESERVE src0_sel:BYTE_1 src1_sel:BYTE_1
    v_sub_u32_sdwa v55, v87, v23 dst_sel:BYTE_2 dst_unused:UNUSED_PRESERVE src0_sel:BYTE_2 src1_sel:BYTE_2
    v_sub_u32_sdwa v56, v88, v24 dst_sel:BYTE_2 dst_unused:UNUSED_PRESERVE src0_sel:BYTE_2 src1_sel:BYTE_2
    v_sub_u32_sdwa v57, v89, v25 dst_sel:BYTE_2 dst_unused:UNUSED_PRESERVE src0_sel:BYTE_2 src1_sel:BYTE_2
    v_sub_u32_sdwa v58, v90, v26 dst_sel:BYTE_2 dst_unused:UNUSED_PRESERVE src0_sel:BYTE_2 src1_sel:BYTE_2
    v_sub_u32_sdwa v59, v91, v27 dst_sel:BYTE_2 dst_unused:UNUSED_PRESERVE src0_sel:BYTE_2 src1_sel:BYTE_2
    v_sub_u32_sdwa v60, v92, v28 dst_sel:BYTE_2 dst_unused:UNUSED_PRESERVE src0_sel:BYTE_2 src1_sel:BYTE_2
    v_dot4_i32_i8 v55, v55, v55, 0
    v_dot4_i32_i8 v56, v56, v56, 0
    v_dot4_i32_i8 v57, v57, v57, 0
    v_dot4_i32_i8 v58, v58, v58, 0
    v_dot4_i32_i8 v59, v59, v59, 0
    v_dot4_i32_i8 v60, v60, v60, 0
    v_lshl_add_u32 v119, v187, 2, s71
    v_lshl_add_u32 v120, v188, 2, s71
    v_lshl_add_u32 v121, v189, 2, s71
    v_lshl_add_u32 v122, v190, 2, s71
    v_lshl_add_u32 v123, v191, 2, s71
    v_lshl_add_u32 v124, v192, 2, s71
    v_cmp_gt_u32 s[66:67], s70, v55
    v_cmp_gt_u32 s[76:77], s70, v56
    v_cmp_gt_u32 s[78:79], s70, v57
    v_cmp_gt_u32 s[80:81], s70, v58
    v_cmp_gt_u32 s[82:83], s70, v59
    s_and_b32 s68, s25, 3
    s_cmp_eq_u32 s68, 3
    s_cselect_b32 s68, 14, 13
    s_bfm_b64 exec, s68, 0
    v_cmp_gt_u32 s[84:85], s70, v60
    s_mov_b64 exec, s[66:67]
    ds_add_rtn_u32 v119, v119, v176
    s_mov_b64 exec, s[76:77]
    ds_add_rtn_u32 v120, v120, v176
    s_mov_b64 exec, s[78:79]
    ds_add_rtn_u32 v121, v121, v176
    s_mov_b64 exec, s[80:81]
    ds_add_rtn_u32 v122, v122, v176
    s_mov_b64 exec, s[82:83]
    ds_add_rtn_u32 v123, v123, v176
    s_mov_b64 exec, s[84:85]
    ds_add_rtn_u32 v124, v124, v176
    s_mov_b64 exec, -1
    s_waitcnt lgkmcnt(11)
    v_lshl_add_u32 v180, v180, 4, v112
    v_cmp_gt_u32 vcc, 16, v112
    v_lshl_add_u32 v80, v180, 1, s73
    v_add_u32 v180, s69, v180
    s_and_b64 exec, vcc, s[52:53]
    s_xor_b64 s[52:53], exec, s[52:53]
    ds_write_b16 v80, v216
    ds_write_b8 v180, v194
    s_mov_b64 exec, -1
    s_or_b64 s[74:75], s[74:75], s[52:53]
    v_lshl_add_u32 v181, v181, 4, v113
    v_cmp_gt_u32 vcc, 16, v113
    v_lshl_add_u32 v81, v181, 1, s73
    v_add_u32 v181, s69, v181
    s_and_b64 exec, vcc, s[54:55]
    s_xor_b64 s[54:55], exec, s[54:55]
    ds_write_b16 v81, v217
    ds_write_b8 v181, v195
    s_mov_b64 exec, -1
    s_or_b64 s[74:75], s[74:75], s[54:55]
    s_waitcnt lgkmcnt(13)
    v_lshl_add_u32 v182, v182, 4, v114
    v_cmp_gt_u32 vcc, 16, v114
    v_lshl_add_u32 v82, v182, 1, s73
    v_add_u32 v182, s69, v182
    s_and_b64 exec, vcc, s[56:57]
    s_xor_b64 s[56:57], exec, s[56:57]
    ds_write_b16 v82, v218
    ds_write_b8 v182, v196
    s_mov_b64 exec, -1
    s_or_b64 s[74:75], s[74:75], s[56:57]
    v_lshl_add_u32 v183, v183, 4, v115
    v_cmp_gt_u32 vcc, 16, v115
    v_lshl_add_u32 v83, v183, 1, s73
    v_add_u32 v183, s69, v183
    s_and_b64 exec, vcc, s[58:59]
    s_xor_b64 s[58:59], exec, s[58:59]
    ds_write_b16 v83, v219
    ds_write_b8 v183, v197
    s_mov_b64 exec, -1
    s_or_b64 s[74:75], s[74:75], s[58:59]
    s_waitcnt lgkmcnt(14)
    v_lshl_add_u32 v184, v184, 4, v116
    v_cmp_gt_u32 vcc, 16, v116
    v_lshl_add_u32 v84, v184, 1, s73
    v_add_u32 v184, s69, v184
    s_and_b64 exec, vcc, s[60:61]
    s_xor_b64 s[60:61], exec, s[60:61]
    ds_write_b16 v84, v220
    ds_write_b8 v184, v198
    s_mov_b64 exec, -1
    s_or_b64 s[74:75], s[74:75], s[60:61]
    v_lshl_add_u32 v185, v185, 4, v117
    v_cmp_gt_u32 vcc, 16, v117
    v_lshl_add_u32 v85, v185, 1, s73
    v_add_u32 v185, s69, v185
    s_and_b64 exec, vcc, s[62:63]
    s_xor_b64 s[62:63], exec, s[62:63]
    ds_write_b16 v85, v221
    ds_write_b8 v185, v199
    s_mov_b64 exec, -1
    s_or_b64 s[74:75], s[74:75], s[62:63]
    v_lshl_add_u32 v186, v186, 4, v118
    v_cmp_gt_u32 vcc, 16, v118
    v_lshl_add_u32 v86, v186, 1, s73
    v_add_u32 v186, s69, v186
    s_and_b64 exec, vcc, s[64:65]
    s_xor_b64 s[64:65], exec, s[64:65]
    ds_write_b16 v86, v222
    ds_write_b8 v186, v200
    s_mov_b64 exec, -1
    s_or_b64 s[74:75], s[74:75], s[64:65]
    s_waitcnt lgkmcnt(14)
    v_lshl_add_u32 v187, v187, 4, v119
    v_cmp_gt_u32 vcc, 16, v119
    v_lshl_add_u32 v87, v187, 1, s73
    v_add_u32 v187, s69, v187
    s_and_b64 exec, vcc, s[66:67]
    s_xor_b64 s[66:67], exec, s[66:67]
    ds_write_b16 v87, v223
    ds_write_b8 v187, v201
    s_mov_b64 exec, -1
    s_or_b64 s[74:75], s[74:75], s[66:67]
    v_lshl_add_u32 v188, v188, 4, v120
    v_cmp_gt_u32 vcc, 16, v120
    v_lshl_add_u32 v88, v188, 1, s73
    v_add_u32 v188, s69, v188
    s_and_b64 exec, vcc, s[76:77]
    s_xor_b64 s[76:77], exec, s[76:77]
    ds_write_b16 v88, v224
    ds_write_b8 v188, v202
    s_mov_b64 exec, -1
    s_or_b64 s[74:75], s[74:75], s[76:77]
    v_lshl_add_u32 v189, v189, 4, v121
    v_cmp_gt_u32 vcc, 16, v121
    v_lshl_add_u32 v89, v189, 1, s73
    v_add_u32 v189, s69, v189
    s_and_b64 exec, vcc, s[78:79]
    s_xor_b64 s[78:79], exec, s[78:79]
    ds_write_b16 v89, v225
    ds_write_b8 v189, v203
    s_mov_b64 exec, -1
    s_or_b64 s[74:75], s[74:75], s[78:79]
    v_lshl_add_u32 v190, v190, 4, v122
    v_cmp_gt_u32 vcc, 16, v122
    v_lshl_add_u32 v90, v190, 1, s73
    v_add_u32 v190, s69, v190
    s_and_b64 exec, vcc, s[80:81]
    s_xor_b64 s[80:81], exec, s[80:81]
    ds_write_b16 v90, v226
    ds_write_b8 v190, v204
    s_mov_b64 exec, -1
    s_or_b64 s[74:75], s[74:75], s[80:81]
    v_lshl_add_u32 v191, v191, 4, v123
    v_cmp_gt_u32 vcc, 16, v123
    v_lshl_add_u32 v91, v191, 1, s73
    v_add_u32 v191, s69, v191
    s_and_b64 exec, vcc, s[82:83]
    s_xor_b64 s[82:83], exec, s[82:83]
    ds_write_b16 v91, v227
    ds_write_b8 v191, v205
    s_mov_b64 exec, -1
    s_or_b64 s[74:75], s[74:75], s[82:83]
    v_lshl_add_u32 v192, v192, 4, v124
    v_cmp_gt_u32 vcc, 16, v124
    v_lshl_add_u32 v92, v192, 1, s73
    v_add_u32 v192, s69, v192
    s_and_b64 exec, vcc, s[84:85]
    s_xor_b64 s[84:85], exec, s[84:85]
    ds_write_b16 v92, v228
    ds_write_b8 v192, v206
    s_mov_b64 exec, -1
    s_or_b64 s[74:75], s[74:75], s[84:85]
    s_cbranch_scc0 F_noovf
    v_mov_b32 v178, 163328
    s_mov_b64 exec, s[52:53]
    ds_add_rtn_u32 v179, v178, v176
    v_mul_u32_u24 v48, s32, v230
    v_lshrrev_b32 v48, 24, v48
    ds_max_u32 v178, v48 offset:8
    v_sub_u32 v48, 255, v48
    ds_max_u32 v178, v48 offset:4
    v_lshl_or_b32 v48, v230, 16, v216
    s_waitcnt lgkmcnt(2)
    v_lshlrev_b32 v179, 2, v179
    buffer_store_dword v48, v179, s[16:19], s72 offen sc1
    s_mov_b64 exec, s[54:55]
    ds_add_rtn_u32 v179, v178, v176
    v_mul_u32_u24 v48, s32, v231
    v_lshrrev_b32 v48, 24, v48
    ds_max_u32 v178, v48 offset:8
    v_sub_u32 v48, 255, v48
    ds_max_u32 v178, v48 offset:4
    v_lshl_or_b32 v48, v231, 16, v217
    s_waitcnt lgkmcnt(2)
    v_lshlrev_b32 v179, 2, v179
    buffer_store_dword v48, v179, s[16:19], s72 offen sc1
    s_mov_b64 exec, s[56:57]
    ds_add_rtn_u32 v179, v178, v176
    v_mul_u32_u24 v48, s32, v232
    v_lshrrev_b32 v48, 24, v48
    ds_max_u32 v178, v48 offset:8
    v_sub_u32 v48, 255, v48
    ds_max_u32 v178, v48 offset:4
    v_lshl_or_b32 v48, v232, 16, v218
    s_waitcnt lgkmcnt(2)
    v_lshlrev_b32 v179, 2, v179
    buffer_store_dword v48, v179, s[16:19], s72 offen sc1
    s_mov_b64 exec, s[58:59]
    ds_add_rtn_u32 v179, v178, v176
    v_mul_u32_u24 v48, s32, v233
    v_lshrrev_b32 v48, 24, v48
    ds_max_u32 v178, v48 offset:8
    v_sub_u32 v48, 255, v48
    ds_max_u32 v178, v48 offset:4
    v_lshl_or_b32 v48, v233, 16, v219
    s_waitcnt lgkmcnt(2)
    v_lshlrev_b32 v179, 2, v179
    buffer_store_dword v48, v179, s[16:19], s72 offen sc1
    s_mov_b64 exec, s[60:61]
    ds_add_rtn_u32 v179, v178, v176
    v_mul_u32_u24 v48, s32, v234
    v_lshrrev_b32 v48, 24, v48
    ds_max_u32 v178, v48 offset:8
    v_sub_u32 v48, 255, v48
    ds_max_u32 v178, v48 offset:4
    v_lshl_or_b32 v48, v234, 16, v220
    s_waitcnt lgkmcnt(2)
    v_lshlrev_b32 v179, 2, v179
    buffer_store_dword v48, v179, s[16:19], s72 offen sc1
    s_mov_b64 exec, s[62:63]
    ds_add_rtn_u32 v179, v178, v176
    v_mul_u32_u24 v48, s32, v235
    v_lshrrev_b32 v48, 24, v48
    ds_max_u32 v178, v48 offset:8
    v_sub_u32 v48, 255, v48
    ds_max_u32 v178, v48 offset:4
    v_lshl_or_b32 v48, v235, 16, v221
    s_waitcnt lgkmcnt(2)
    v_lshlrev_b32 v179, 2, v179
    buffer_store_dword v48, v179, s[16:19], s72 offen sc1
    s_mov_b64 exec, s[64:65]
    ds_add_rtn_u32 v179, v178, v176
    v_mul_u32_u24 v48, s32, v236
    v_lshrrev_b32 v48, 24, v48
    ds_max_u32 v178, v48 offset:8
    v_sub_u32 v48, 255, v48
    ds_max_u32 v178, v48 offset:4
    v_lshl_or_b32 v48, v236, 16, v222
    s_waitcnt lgkmcnt(2)
    v_lshlrev_b32 v179, 2, v179
    buffer_store_dword v48, v179, s[16:19], s72 offen sc1
    s_mov_b64 exec, s[66:67]
    ds_add_rtn_u32 v179, v178, v176
    v_mul_u32_u24 v48, s32, v237
    v_lshrrev_b32 v48, 24, v48
    ds_max_u32 v178, v48 offset:8
    v_sub_u32 v48, 255, v48
    ds_max_u32 v178, v48 offset:4
    v_lshl_or_b32 v48, v237, 16, v223
    s_waitcnt lgkmcnt(2)
    v_lshlrev_b32 v179, 2, v179
    buffer_store_dword v48, v179, s[16:19], s72 offen sc1
    s_mov_b64 exec, s[76:77]
    ds_add_rtn_u32 v179, v178, v176
    v_mul_u32_u24 v48, s32, v238
    v_lshrrev_b32 v48, 24, v48
    ds_max_u32 v178, v48 offset:8
    v_sub_u32 v48, 255, v48
    ds_max_u32 v178, v48 offset:4
    v_lshl_or_b32 v48, v238, 16, v224
    s_waitcnt lgkmcnt(2)
    v_lshlrev_b32 v179, 2, v179
    buffer_store_dword v48, v179, s[16:19], s72 offen sc1
    s_mov_b64 exec, s[78:79]
    ds_add_rtn_u32 v179, v178, v176
    v_mul_u32_u24 v48, s32, v239
    v_lshrrev_b32 v48, 24, v48
    ds_max_u32 v178, v48 offset:8
    v_sub_u32 v48, 255, v48
    ds_max_u32 v178, v48 offset:4
    v_lshl_or_b32 v48, v239, 16, v225
    s_waitcnt lgkmcnt(2)
    v_lshlrev_b32 v179, 2, v179
    buffer_store_dword v48, v179, s[16:19], s72 offen sc1
    s_mov_b64 exec, s[80:81]
    ds_add_rtn_u32 v179, v178, v176
    v_mul_u32_u24 v48, s32, v240
    v_lshrrev_b32 v48, 24, v48
    ds_max_u32 v178, v48 offset:8
    v_sub_u32 v48, 255, v48
    ds_max_u32 v178, v48 offset:4
    v_lshl_or_b32 v48, v240, 16, v226
    s_waitcnt lgkmcnt(2)
    v_lshlrev_b32 v179, 2, v179
    buffer_store_dword v48, v179, s[16:19], s72 offen sc1
    s_mov_b64 exec, s[82:83]
    ds_add_rtn_u32 v179, v178, v176
    v_mul_u32_u24 v48, s32, v241
    v_lshrrev_b32 v48, 24, v48
    ds_max_u32 v178, v48 offset:8
    v_sub_u32 v48, 255, v48
    ds_max_u32 v178, v48 offset:4
    v_lshl_or_b32 v48, v241, 16, v227
    s_waitcnt lgkmcnt(2)
    v_lshlrev_b32 v179, 2, v179
    buffer_store_dword v48, v179, s[16:19], s72 offen sc1
    s_mov_b64 exec, s[84:85]
    ds_add_rtn_u32 v179, v178, v176
    v_mul_u32_u24 v48, s32, v242
    v_lshrrev_b32 v48, 24, v48
    ds_max_u32 v178, v48 offset:8
    v_sub_u32 v48, 255, v48
    ds_max_u32 v178, v48 offset:4
    v_lshl_or_b32 v48, v242, 16, v228
    s_waitcnt lgkmcnt(2)
    v_lshlrev_b32 v179, 2, v179
    buffer_store_dword v48, v179, s[16:19], s72 offen sc1
    s_mov_b64 exec, -1
    s_waitcnt vmcnt(0)
F_noovf:
    s_lshl_b32 s68, s25, 6
    v_lshrrev_b32 v160, 4, v247
    v_add_u32 v160, s68, v160
    v_lshlrev_b32 v161, 4, v160
    v_lshlrev_b32 v162, 3, v160
    v_add_u32 v162, 150016, v162
    v_lshlrev_b32 v163, 2, v160
    v_add_u32 v163, 158208, v163
    v_mov_b32 v165, 163328
    s_mul_i32 s69, s49, 16384
    s_add_u32 s69, s69, 256
    s_add_u32 s70, s69, 8192
    s_mov_b32 s52, 0x0c040100
    s_mov_b32 s53, 0x0c050302
    s_mov_b32 s54, 0x0c060100
    s_mov_b32 s55, 0x0c070302
    s_waitcnt lgkmcnt(0)
    s_barrier
    ds_read_b64 v[184:185], v162
    ds_read_b32 v188, v163
    ds_read_b64 v[186:187], v162 offset:4096
    ds_read_b32 v189, v163 offset:2048
    ds_read_b32 v190, v165
    ds_read2_b32 v[166:167], v165 offset0:1 offset1:2
    s_waitcnt lgkmcnt(2)
    v_perm_b32 v176, v188, v184, s52
    v_perm_b32 v177, v188, v184, s53
    v_perm_b32 v178, v188, v185, s54
    v_perm_b32 v179, v188, v185, s55
    v_or_b32 v176, s44, v176
    v_or_b32 v177, s45, v177
    v_or_b32 v178, s46, v178
    v_or_b32 v179, s47, v179
    buffer_store_dwordx4 v[176:179], v161, s[16:19], s69 offen sc1
    v_perm_b32 v180, v189, v186, s52
    v_perm_b32 v181, v189, v186, s53
    v_perm_b32 v182, v189, v187, s54
    v_perm_b32 v183, v189, v187, s55
    v_or_b32 v180, s44, v180
    v_or_b32 v181, s45, v181
    v_or_b32 v182, s46, v182
    v_or_b32 v183, s47, v183
    buffer_store_dwordx4 v[180:183], v161, s[16:19], s70 offen sc1
    s_cmp_lg_u32 s25, 0
    s_waitcnt lgkmcnt(0)
    s_cbranch_scc1 F_nostat
    v_or_b32 v160, s44, v190
    v_or_b32 v161, s45, v166
    v_or_b32 v162, s46, v167
    v_mov_b32 v163, s47
    v_mov_b32 v164, 0
    s_lshl_b32 s68, s49, 4
    s_add_u32 s68, s68, 2097408
    s_mov_b64 exec, 1
    buffer_store_dwordx4 v[160:163], v164, s[16:19], s68 offen sc1
    s_lshl_b32 s68, s49, 7
    s_add_u32 s68, s68, 2101504
    buffer_store_dwordx4 v[160:163], v164, s[16:19], s68 offen sc1
    s_mov_b64 exec, -1
F_nostat:
    s_barrier
    buffer_load_dword v1, v246, s[8:11], s34 offen offset:512
    buffer_load_dword v33, v246, s[8:11], s34 offen offset:640
    buffer_load_dword v2, v246, s[8:11], s34 offen offset:1024
    buffer_load_dword v34, v246, s[8:11], s34 offen offset:1152
    buffer_load_dword v3, v246, s[8:11], s34 offen offset:1536
    buffer_load_dword v35, v246, s[8:11], s34 offen offset:1664
    buffer_load_dword v4, v246, s[8:11], s35 offen offset:0
    buffer_load_dword v36, v246, s[8:11], s35 offen offset:128
    buffer_load_dword v5, v246, s[8:11], s35 offen offset:512
    buffer_load_dword v37, v246, s[8:11], s35 offen offset:640
    buffer_load_dword v6, v246, s[8:11], s35 offen offset:1024
    buffer_load_dword v38, v246, s[8:11], s35 offen offset:1152
    buffer_load_dword v7, v246, s[8:11], s35 offen offset:1536
    buffer_load_dword v39, v246, s[8:11], s35 offen offset:1664
    buffer_load_dword v8, v246, s[8:11], s36 offen offset:0
    buffer_load_dword v40, v246, s[8:11], s36 offen offset:128
    buffer_load_dword v9, v246, s[8:11], s36 offen offset:512
    buffer_load_dword v41, v246, s[8:11], s36 offen offset:640
    buffer_load_dword v10, v246, s[8:11], s36 offen offset:1024
    buffer_load_dword v42, v246, s[8:11], s36 offen offset:1152
    buffer_load_dword v11, v246, s[8:11], s36 offen offset:1536
    buffer_load_dword v43, v246, s[8:11], s36 offen offset:1664
    buffer_load_dword v12, v246, s[8:11], s37 offen offset:0
    buffer_load_dword v44, v246, s[8:11], s37 offen offset:128
    s_waitcnt vmcnt(54)
    s_mov_b32 s72, 0x05040100
    s_mov_b32 s73, 0x07060302
    v_perm_b32 v144, v129, v128, s72
    v_perm_b32 v145, v131, v130, s72
    v_perm_b32 v146, v133, v132, s72
    v_perm_b32 v147, v135, v134, s72
    v_perm_b32 v148, v129, v128, s73
    v_perm_b32 v149, v131, v130, s73
    v_perm_b32 v150, v133, v132, s73
    v_perm_b32 v151, v135, v134, s73
    s_lshr_b32 s68, s25, 2
    s_lshl_b32 s68, s68, 13
    s_and_b32 s69, s25, 3
    s_lshl_b32 s69, s69, 10
    s_add_u32 s68, s68, s69
    v_add_u32 v251, s68, v247
    ds_write_b128 v251, v[144:147]
    ds_write_b128 v251, v[148:151] offset:4096
    s_cmp_ge_u32 s25, 4
    s_cbranch_scc1 F_wf2
    s_add_u32 s70, s25, 8
    v_perm_b32 v144, v137, v136, s72
    v_perm_b32 v145, v139, v138, s72
    v_perm_b32 v146, v141, v140, s72
    v_perm_b32 v147, v143, v142, s72
    v_perm_b32 v148, v137, v136, s73
    v_perm_b32 v149, v139, v138, s73
    v_perm_b32 v150, v141, v140, s73
    v_perm_b32 v151, v143, v142, s73
    s_lshr_b32 s68, s70, 2
    s_lshl_b32 s68, s68, 13
    s_and_b32 s69, s70, 3
    s_lshl_b32 s69, s69, 10
    s_add_u32 s68, s68, s69
    v_add_u32 v251, s68, v247
    ds_write_b128 v251, v[144:147]
    ds_write_b128 v251, v[148:151] offset:4096
    s_branch F_wf3
F_wf2:
    s_cmp_ge_u32 s25, 7
    s_cbranch_scc1 F_wf3
    v_perm_b32 v144, v175, v174, s72
    v_perm_b32 v146, v175, v174, s73
    v_mov_b32 v145, 0
    v_mov_b32 v147, 0
    s_lshl_b32 s68, s25, 11
    s_add_u32 s68, s68, 16384
    v_add_u32 v251, s68, v247
    ds_write_b64 v251, v[144:145]
    ds_write_b64 v251, v[146:147] offset:1024
F_wf3:
    v_mov_b32 v172, 0
    v_mov_b32 v173, 0
    v_mov_b32 v174, 0
    v_mov_b32 v175, 0
    v_add_u32 v170, s29, v247
    ds_write_b128 v170, v[172:175]
    ds_write_b128 v170, v[172:175] offset:640
    v_mov_b32 v170, 44032
    ds_write_b128 v170, v[172:175]
    ds_write_b128 v170, v[172:175] offset:16
    ds_write_b128 v170, v[172:175] offset:32
    s_mov_b32 s50, 0
    s_branch F_joined
F_streamer:
    s_lshl_b32 s32, s49, 4
    s_add_u32 s49, s49, 128
    s_sub_u32 s50, s26, 3136
    v_lshl_add_u32 v112, v249, 6, v248
    s_lshl_b32 s68, s25, 11
    buffer_load_dword v216, v112, s[84:87], s68 offen offset:0
    buffer_load_dword v217, v112, s[84:87], s68 offen offset:128
    buffer_load_dword v218, v112, s[84:87], s68 offen offset:256
    buffer_load_dword v219, v112, s[84:87], s68 offen offset:384
    buffer_load_dword v220, v112, s[84:87], s68 offen offset:512
    buffer_load_dword v221, v112, s[84:87], s68 offen offset:640
    buffer_load_dword v222, v112, s[84:87], s68 offen offset:768
    buffer_load_dword v223, v112, s[84:87], s68 offen offset:896
    s_load_dword s48, s[16:17], 0
    s_load_dwordx2 s[96:97], s[52:53], 0
    s_sub_u32 s4, s8, 3072
    s_subb_u32 s5, s9, 0
    v_lshrrev_b32 v114, 8, v247
    v_lshlrev_b32 v114, 4, v114
    v_and_b32 v115, 0x70, v247
    v_xor_b32 v114, v114, v115
    v_and_b32 v115, 0x380, v247
    v_lshl_add_u32 v112, v115, 2, v114
    v_xor_b32 v113, 64, v112
    v_add_u32 v120, v115, v114
    v_xor_b32 v121, 64, v120
    s_lshl_b32 s68, s26, 9
    s_add_u32 m0, s27, 0
    s_add_u32 s69, s68, 0
    buffer_load_dwordx4 v112, s[8:11], s69 offen lds
    s_add_u32 m0, s27, 1024
    s_add_u32 s69, s68, 4096
    buffer_load_dwordx4 v113, s[8:11], s69 offen lds
    s_add_u32 m0, s27, 2048
    s_add_u32 s69, s68, 8192
    buffer_load_dwordx4 v112, s[8:11], s69 offen lds
    s_mov_b64 exec, 0xff
    s_add_u32 m0, s27, 3072
    s_add_u32 s69, s68, 12288
    buffer_load_dwordx4 v113, s[8:11], s69 offen lds
    s_mov_b64 exec, -1
    s_lshl_b32 s68, s50, 9
    s_add_u32 m0, s27, 4096
    s_add_u32 s69, s68, 0
    buffer_load_dwordx4 v112, s[8:11], s69 offen lds
    s_add_u32 m0, s27, 5120
    s_add_u32 s69, s68, 4096
    buffer_load_dwordx4 v113, s[8:11], s69 offen lds
    s_add_u32 m0, s27, 6144
    s_add_u32 s69, s68, 8192
    buffer_load_dwordx4 v112, s[8:11], s69 offen lds
    s_mov_b64 exec, 0xff
    s_add_u32 m0, s27, 7168
    s_add_u32 s69, s68, 12288
    buffer_load_dwordx4 v113, s[8:11], s69 offen lds
    s_mov_b64 exec, -1
    buffer_load_dwordx4 v[124:127], v247, s[76:79], s30 offen offset:0
    buffer_load_dwordx4 v[124:127], v247, s[76:79], s30 offen offset:1024
    buffer_load_dwordx4 v[124:127], v247, s[76:79], s30 offen offset:2048
    buffer_load_dword v124, v248, s[76:79], s30 offen offset:3072
    buffer_load_dwordx4 v[124:127], v247, s[80:83], s30 offen offset:0
    buffer_load_dwordx4 v[124:127], v247, s[80:83], s30 offen offset:1024
    buffer_load_dwordx4 v[124:127], v247, s[80:83], s30 offen offset:2048
    buffer_load_dword v124, v248, s[80:83], s30 offen offset:3072
    s_movk_i32 s38, 128
    s_movk_i32 s39, 3200
    s_movk_i32 s40, 512
    v_mul_u32_u24 v255, 8, v249
    v_add3_u32 v255, v255, v248, s27
    v_lshrrev_b32 v170, 1, v248
    v_and_b32 v171, 0x26, v170
    v_and_b32 v172, 8, v170
    v_lshl_or_b32 v171, v172, 1, v171
    v_and_b32 v172, 16, v170
    v_lshrrev_b32 v172, 1, v172
    v_or_b32 v210, v171, v172
    v_lshlrev_b32 v210, 24, v210
    v_and_b32 v170, 0x30, v248
    v_xor_b32 v170, v249, v170
    v_lshl_add_u32 v170, v248, 4, v170
    v_add_u32 v211, s29, v170
    v_xor_b32 v250, 32, v211
    v_mov_b32 v243, 0
    v_xor_b32 v244, 4, v248
    v_lshrrev_b32 v170, 2, v249
    v_lshl_add_u32 v244, v244, 1, v170
    v_and_b32 v243, 0x70, v247
    v_lshrrev_b32 v212, 3, v247
    v_and_b32 v212, 0x70, v212
    v_and_b32 v210, 0xffffff, v210
    v_lshl_or_b32 v210, v212, 24, v210
    v_lshrrev_b32 v212, 2, v247
    v_and_b32 v212, 64, v212
    v_xor_b32 v245, v212, v247
    v_add_u32 v245, s27, v245
    v_and_b32 v212, 12, v248
    v_lshlrev_b32 v213, 2, v212
    v_lshlrev_b32 v212, 8, v212
    v_and_b32 v214, 0x70, v248
    v_lshl_add_u32 v212, v214, 3, v212
    v_lshlrev_b32 v214, 1, v248
    v_and_b32 v214, 64, v214
    v_or_b32 v213, v213, v214
    v_xor_b32 v213, v249, v213
    v_add3_u32 v212, v212, v213, s27
    v_xor_b32 v213, 32, v212
    v_xor_b32 v214, 64, v212
    v_xor_b32 v215, 0x60, v212
    v_lshlrev_b32 v116, 1, v248
    v_and_b32 v116, 0x70, v116
    v_xor_b32 v116, v249, v116
    v_lshl_add_u32 v116, v248, 5, v116
    v_xor_b32 v119, 96, v116
    v_add_u32 v119, s27, v119
    v_xor_b32 v118, 64, v116
    v_add_u32 v118, s27, v118
    v_xor_b32 v117, 32, v116
    v_add_u32 v117, s27, v117
    v_xor_b32 v116, 0, v116
    v_add_u32 v116, s27, v116
    s_add_u32 s76, s16, 5317888
    s_addc_u32 s77, s17, 0
    s_mov_b32 s78, 6400000
    s_mov_b32 s79, 0x20000
    s_mov_b32 s72, 0x05040100
    s_mov_b32 s73, 0x07060302
    s_mov_b32 s52, 0xbfb8aa3b
    s_mov_b32 s53, 0xbfb8aa3b
    s_waitcnt vmcnt(16)
    s_cmp_ge_u32 s25, 4
    s_cbranch_scc1 F_now1
    v_perm_b32 v80, v217, v216, s72
    v_perm_b32 v81, v219, v218, s72
    v_perm_b32 v82, v221, v220, s72
    v_perm_b32 v83, v223, v222, s72
    v_perm_b32 v84, v217, v216, s73
    v_perm_b32 v85, v219, v218, s73
    v_perm_b32 v86, v221, v220, s73
    v_perm_b32 v87, v223, v222, s73
    s_lshl_b32 s68, s25, 10
    v_add_u32 v251, s68, v247
    ds_write_b128 v251, v[80:83] offset:0
    ds_write_b128 v251, v[84:87] offset:4096
F_now1:
    s_waitcnt lgkmcnt(0)
    s_add_u32 s48, s48, 1
    s_lshr_b32 s68, s48, 8
    s_xor_b32 s68, s68, s48
    s_and_b32 s68, s68, 0xff
    s_cselect_b32 s68, 0, 0x8000
    s_xor_b32 s51, s48, s68
    s_lshl_b32 s44, s51, 24
    s_lshl_b32 s45, s51, 16
    s_and_b32 s45, s45, 0xff000000
    s_lshl_b32 s46, s51, 8
    s_and_b32 s46, s46, 0xff000000
    s_and_b32 s47, s51, 0xff000000
    s_barrier
    ds_read_b128 v[144:147], v247 offset:0
    ds_read_b128 v[148:151], v247 offset:1024
    ds_read_b128 v[152:155], v247 offset:2048
    ds_read_b128 v[156:159], v247 offset:3072
    ds_read_b128 v[160:163], v247 offset:4096
    ds_read_b128 v[164:167], v247 offset:5120
    ds_read_b128 v[168:171], v247 offset:6144
    ds_read_b128 v[172:175], v247 offset:7168
    v_add_u32 v251, s27, v247
    s_waitcnt vmcnt(12)
    ds_read_b128 v[16:19], v116 offset:0
    ds_read_b128 v[20:23], v117 offset:0
    ds_read_b128 v[24:27], v118 offset:0
    ds_read_b128 v[28:31], v119 offset:0
    s_waitcnt lgkmcnt(0)
    v_mfma_f32_32x32x16_bf16 v[176:191], v[144:147], v[16:19], 0
    v_mfma_f32_32x32x16_bf16 v[176:191], v[148:151], v[20:23], v[176:191]
    v_mfma_f32_32x32x16_bf16 v[176:191], v[152:155], v[24:27], v[176:191]
    v_mfma_f32_32x32x16_bf16 v[176:191], v[156:159], v[28:31], v[176:191]
    v_mfma_f32_32x32x16_bf16 v[192:207], v[160:163], v[16:19], 0
    v_mfma_f32_32x32x16_bf16 v[192:207], v[164:167], v[20:23], v[192:207]
    v_mfma_f32_32x32x16_bf16 v[192:207], v[168:171], v[24:27], v[192:207]
    v_mfma_f32_32x32x16_bf16 v[192:207], v[172:175], v[28:31], v[192:207]
    buffer_load_dword v0, v246, s[8:11], s34 offen offset:0
    buffer_load_dword v32, v246, s[8:11], s34 offen offset:128
    buffer_load_dword v64, v246, s[8:11], s34 offen offset:256
    buffer_load_dword v96, v246, s[8:11], s34 offen offset:384
    buffer_load_dword v1, v246, s[8:11], s34 offen offset:512
    buffer_load_dword v33, v246, s[8:11], s34 offen offset:640
    buffer_load_dword v65, v246, s[8:11], s34 offen offset:768
    s_nop 0
    v_pk_mul_f32 v[48:49], v[176:177], s[52:53]
    v_pk_mul_f32 v[50:51], v[178:179], s[52:53]
    v_pk_mul_f32 v[52:53], v[180:181], s[52:53]
    v_pk_mul_f32 v[54:55], v[182:183], s[52:53]
    v_exp_f32 v48, v48
    v_exp_f32 v49, v49
    v_exp_f32 v50, v50
    v_exp_f32 v51, v51
    v_exp_f32 v52, v52
    v_exp_f32 v53, v53
    v_exp_f32 v54, v54
    v_exp_f32 v55, v55
    v_add_f32 v48, 1.0, v48
    v_add_f32 v49, 1.0, v49
    v_add_f32 v50, 1.0, v50
    v_add_f32 v51, 1.0, v51
    v_add_f32 v52, 1.0, v52
    v_add_f32 v53, 1.0, v53
    v_add_f32 v54, 1.0, v54
    v_add_f32 v55, 1.0, v55
    v_rcp_f32 v48, v48
    v_rcp_f32 v49, v49
    v_rcp_f32 v50, v50
    v_rcp_f32 v51, v51
    v_rcp_f32 v52, v52
    v_rcp_f32 v53, v53
    v_rcp_f32 v54, v54
    v_rcp_f32 v55, v55
    v_pk_mul_f32 v[176:177], v[176:177], v[48:49]
    v_pk_mul_f32 v[178:179], v[178:179], v[50:51]
    v_pk_mul_f32 v[180:181], v[180:181], v[52:53]
    v_pk_mul_f32 v[182:183], v[182:183], v[54:55]
    v_cvt_pk_bf16_f32 v80, v176, v177
    v_cvt_pk_bf16_f32 v81, v178, v179
    v_cvt_pk_bf16_f32 v82, v180, v181
    v_cvt_pk_bf16_f32 v83, v182, v183
    buffer_load_dword v97, v246, s[8:11], s34 offen offset:896
    buffer_load_dword v2, v246, s[8:11], s34 offen offset:1024
    buffer_load_dword v34, v246, s[8:11], s34 offen offset:1152
    buffer_load_dword v66, v246, s[8:11], s34 offen offset:1280
    buffer_load_dword v98, v246, s[8:11], s34 offen offset:1408
    buffer_load_dword v3, v246, s[8:11], s34 offen offset:1536
    buffer_load_dword v35, v246, s[8:11], s34 offen offset:1664
    v_pk_mul_f32 v[56:57], v[184:185], s[52:53]
    v_pk_mul_f32 v[58:59], v[186:187], s[52:53]
    v_pk_mul_f32 v[60:61], v[188:189], s[52:53]
    v_pk_mul_f32 v[62:63], v[190:191], s[52:53]
    v_exp_f32 v56, v56
    v_exp_f32 v57, v57
    v_exp_f32 v58, v58
    v_exp_f32 v59, v59
    v_exp_f32 v60, v60
    v_exp_f32 v61, v61
    v_exp_f32 v62, v62
    v_exp_f32 v63, v63
    v_add_f32 v56, 1.0, v56
    v_add_f32 v57, 1.0, v57
    v_add_f32 v58, 1.0, v58
    v_add_f32 v59, 1.0, v59
    v_add_f32 v60, 1.0, v60
    v_add_f32 v61, 1.0, v61
    v_add_f32 v62, 1.0, v62
    v_add_f32 v63, 1.0, v63
    v_rcp_f32 v56, v56
    v_rcp_f32 v57, v57
    v_rcp_f32 v58, v58
    v_rcp_f32 v59, v59
    v_rcp_f32 v60, v60
    v_rcp_f32 v61, v61
    v_rcp_f32 v62, v62
    v_rcp_f32 v63, v63
    v_pk_mul_f32 v[184:185], v[184:185], v[56:57]
    v_pk_mul_f32 v[186:187], v[186:187], v[58:59]
    v_pk_mul_f32 v[188:189], v[188:189], v[60:61]
    v_pk_mul_f32 v[190:191], v[190:191], v[62:63]
    v_cvt_pk_bf16_f32 v84, v184, v185
    v_cvt_pk_bf16_f32 v85, v186, v187
    v_cvt_pk_bf16_f32 v86, v188, v189
    v_cvt_pk_bf16_f32 v87, v190, v191
    buffer_load_dword v67, v246, s[8:11], s34 offen offset:1792
    buffer_load_dword v99, v246, s[8:11], s34 offen offset:1920
    buffer_load_dword v4, v246, s[8:11], s35 offen offset:0
    buffer_load_dword v36, v246, s[8:11], s35 offen offset:128
    buffer_load_dword v68, v246, s[8:11], s35 offen offset:256
    buffer_load_dword v100, v246, s[8:11], s35 offen offset:384
    buffer_load_dword v5, v246, s[8:11], s35 offen offset:512
    v_pk_mul_f32 v[48:49], v[192:193], s[52:53]
    v_pk_mul_f32 v[50:51], v[194:195], s[52:53]
    v_pk_mul_f32 v[52:53], v[196:197], s[52:53]
    v_pk_mul_f32 v[54:55], v[198:199], s[52:53]
    v_exp_f32 v48, v48
    v_exp_f32 v49, v49
    v_exp_f32 v50, v50
    v_exp_f32 v51, v51
    v_exp_f32 v52, v52
    v_exp_f32 v53, v53
    v_exp_f32 v54, v54
    v_exp_f32 v55, v55
    v_add_f32 v48, 1.0, v48
    v_add_f32 v49, 1.0, v49
    v_add_f32 v50, 1.0, v50
    v_add_f32 v51, 1.0, v51
    v_add_f32 v52, 1.0, v52
    v_add_f32 v53, 1.0, v53
    v_add_f32 v54, 1.0, v54
    v_add_f32 v55, 1.0, v55
    v_rcp_f32 v48, v48
    v_rcp_f32 v49, v49
    v_rcp_f32 v50, v50
    v_rcp_f32 v51, v51
    v_rcp_f32 v52, v52
    v_rcp_f32 v53, v53
    v_rcp_f32 v54, v54
    v_rcp_f32 v55, v55
    v_pk_mul_f32 v[192:193], v[192:193], v[48:49]
    v_pk_mul_f32 v[194:195], v[194:195], v[50:51]
    v_pk_mul_f32 v[196:197], v[196:197], v[52:53]
    v_pk_mul_f32 v[198:199], v[198:199], v[54:55]
    v_cvt_pk_bf16_f32 v88, v192, v193
    v_cvt_pk_bf16_f32 v89, v194, v195
    v_cvt_pk_bf16_f32 v90, v196, v197
    v_cvt_pk_bf16_f32 v91, v198, v199
    buffer_load_dword v37, v246, s[8:11], s35 offen offset:640
    buffer_load_dword v69, v246, s[8:11], s35 offen offset:768
    buffer_load_dword v101, v246, s[8:11], s35 offen offset:896
    buffer_load_dword v6, v246, s[8:11], s35 offen offset:1024
    buffer_load_dword v38, v246, s[8:11], s35 offen offset:1152
    buffer_load_dword v70, v246, s[8:11], s35 offen offset:1280
    buffer_load_dword v102, v246, s[8:11], s35 offen offset:1408
    v_pk_mul_f32 v[56:57], v[200:201], s[52:53]
    v_pk_mul_f32 v[58:59], v[202:203], s[52:53]
    v_pk_mul_f32 v[60:61], v[204:205], s[52:53]
    v_pk_mul_f32 v[62:63], v[206:207], s[52:53]
    v_exp_f32 v56, v56
    v_exp_f32 v57, v57
    v_exp_f32 v58, v58
    v_exp_f32 v59, v59
    v_exp_f32 v60, v60
    v_exp_f32 v61, v61
    v_exp_f32 v62, v62
    v_exp_f32 v63, v63
    v_add_f32 v56, 1.0, v56
    v_add_f32 v57, 1.0, v57
    v_add_f32 v58, 1.0, v58
    v_add_f32 v59, 1.0, v59
    v_add_f32 v60, 1.0, v60
    v_add_f32 v61, 1.0, v61
    v_add_f32 v62, 1.0, v62
    v_add_f32 v63, 1.0, v63
    v_rcp_f32 v56, v56
    v_rcp_f32 v57, v57
    v_rcp_f32 v58, v58
    v_rcp_f32 v59, v59
    v_rcp_f32 v60, v60
    v_rcp_f32 v61, v61
    v_rcp_f32 v62, v62
    v_rcp_f32 v63, v63
    v_pk_mul_f32 v[200:201], v[200:201], v[56:57]
    v_pk_mul_f32 v[202:203], v[202:203], v[58:59]
    v_pk_mul_f32 v[204:205], v[204:205], v[60:61]
    v_pk_mul_f32 v[206:207], v[206:207], v[62:63]
    v_cvt_pk_bf16_f32 v92, v200, v201
    v_cvt_pk_bf16_f32 v93, v202, v203
    v_cvt_pk_bf16_f32 v94, v204, v205
    v_cvt_pk_bf16_f32 v95, v206, v207
    ds_write_b128 v116, v[80:83] offset:0
    ds_write_b128 v117, v[84:87] offset:0
    ds_write_b128 v118, v[88:91] offset:0
    ds_write_b128 v119, v[92:95] offset:0
    ds_read_b128 v[16:19], v251 offset:0
    ds_read_b128 v[20:23], v251 offset:1024
    ds_read_b128 v[24:27], v251 offset:2048
    ds_read_b128 v[28:31], v251 offset:3072
    s_lshl_b32 s68, s26, 7
    s_waitcnt lgkmcnt(0)
    buffer_store_dwordx4 v[16:19], v120, s[76:79], s68 offen offset:0 sc1
    buffer_store_dwordx4 v[20:23], v121, s[76:79], s68 offen offset:1024 sc1
    buffer_store_dwordx4 v[24:27], v120, s[76:79], s68 offen offset:2048 sc1
    s_mov_b64 exec, 0xff
    buffer_store_dwordx4 v[28:31], v121, s[76:79], s68 offen offset:3072 sc1
    s_mov_b64 exec, -1
    s_waitcnt vmcnt(40)
    ds_read_b128 v[16:19], v116 offset:4096
    ds_read_b128 v[20:23], v117 offset:4096
    ds_read_b128 v[24:27], v118 offset:4096
    ds_read_b128 v[28:31], v119 offset:4096
    s_waitcnt lgkmcnt(0)
    v_mfma_f32_32x32x16_bf16 v[176:191], v[144:147], v[16:19], 0
    v_mfma_f32_32x32x16_bf16 v[176:191], v[148:151], v[20:23], v[176:191]
    v_mfma_f32_32x32x16_bf16 v[176:191], v[152:155], v[24:27], v[176:191]
    v_mfma_f32_32x32x16_bf16 v[176:191], v[156:159], v[28:31], v[176:191]
    v_mfma_f32_32x32x16_bf16 v[192:207], v[160:163], v[16:19], 0
    v_mfma_f32_32x32x16_bf16 v[192:207], v[164:167], v[20:23], v[192:207]
    v_mfma_f32_32x32x16_bf16 v[192:207], v[168:171], v[24:27], v[192:207]
    v_mfma_f32_32x32x16_bf16 v[192:207], v[172:175], v[28:31], v[192:207]
    buffer_load_dword v7, v246, s[8:11], s35 offen offset:1536
    buffer_load_dword v39, v246, s[8:11], s35 offen offset:1664
    buffer_load_dword v71, v246, s[8:11], s35 offen offset:1792
    buffer_load_dword v103, v246, s[8:11], s35 offen offset:1920
    buffer_load_dword v8, v246, s[8:11], s36 offen offset:0
    buffer_load_dword v40, v246, s[8:11], s36 offen offset:128
    buffer_load_dword v72, v246, s[8:11], s36 offen offset:256
    s_nop 0
    v_pk_mul_f32 v[48:49], v[176:177], s[52:53]
    v_pk_mul_f32 v[50:51], v[178:179], s[52:53]
    v_pk_mul_f32 v[52:53], v[180:181], s[52:53]
    v_pk_mul_f32 v[54:55], v[182:183], s[52:53]
    v_exp_f32 v48, v48
    v_exp_f32 v49, v49
    v_exp_f32 v50, v50
    v_exp_f32 v51, v51
    v_exp_f32 v52, v52
    v_exp_f32 v53, v53
    v_exp_f32 v54, v54
    v_exp_f32 v55, v55
    v_add_f32 v48, 1.0, v48
    v_add_f32 v49, 1.0, v49
    v_add_f32 v50, 1.0, v50
    v_add_f32 v51, 1.0, v51
    v_add_f32 v52, 1.0, v52
    v_add_f32 v53, 1.0, v53
    v_add_f32 v54, 1.0, v54
    v_add_f32 v55, 1.0, v55
    v_rcp_f32 v48, v48
    v_rcp_f32 v49, v49
    v_rcp_f32 v50, v50
    v_rcp_f32 v51, v51
    v_rcp_f32 v52, v52
    v_rcp_f32 v53, v53
    v_rcp_f32 v54, v54
    v_rcp_f32 v55, v55
    v_pk_mul_f32 v[176:177], v[176:177], v[48:49]
    v_pk_mul_f32 v[178:179], v[178:179], v[50:51]
    v_pk_mul_f32 v[180:181], v[180:181], v[52:53]
    v_pk_mul_f32 v[182:183], v[182:183], v[54:55]
    v_cvt_pk_bf16_f32 v80, v176, v177
    v_cvt_pk_bf16_f32 v81, v178, v179
    v_cvt_pk_bf16_f32 v82, v180, v181
    v_cvt_pk_bf16_f32 v83, v182, v183
    buffer_load_dword v104, v246, s[8:11], s36 offen offset:384
    buffer_load_dword v9, v246, s[8:11], s36 offen offset:512
    buffer_load_dword v41, v246, s[8:11], s36 offen offset:640
    buffer_load_dword v73, v246, s[8:11], s36 offen offset:768
    buffer_load_dword v105, v246, s[8:11], s36 offen offset:896
    buffer_load_dword v10, v246, s[8:11], s36 offen offset:1024
    buffer_load_dword v42, v246, s[8:11], s36 offen offset:1152
    v_pk_mul_f32 v[56:57], v[184:185], s[52:53]
    v_pk_mul_f32 v[58:59], v[186:187], s[52:53]
    v_pk_mul_f32 v[60:61], v[188:189], s[52:53]
    v_pk_mul_f32 v[62:63], v[190:191], s[52:53]
    v_exp_f32 v56, v56
    v_exp_f32 v57, v57
    v_exp_f32 v58, v58
    v_exp_f32 v59, v59
    v_exp_f32 v60, v60
    v_exp_f32 v61, v61
    v_exp_f32 v62, v62
    v_exp_f32 v63, v63
    v_add_f32 v56, 1.0, v56
    v_add_f32 v57, 1.0, v57
    v_add_f32 v58, 1.0, v58
    v_add_f32 v59, 1.0, v59
    v_add_f32 v60, 1.0, v60
    v_add_f32 v61, 1.0, v61
    v_add_f32 v62, 1.0, v62
    v_add_f32 v63, 1.0, v63
    v_rcp_f32 v56, v56
    v_rcp_f32 v57, v57
    v_rcp_f32 v58, v58
    v_rcp_f32 v59, v59
    v_rcp_f32 v60, v60
    v_rcp_f32 v61, v61
    v_rcp_f32 v62, v62
    v_rcp_f32 v63, v63
    v_pk_mul_f32 v[184:185], v[184:185], v[56:57]
    v_pk_mul_f32 v[186:187], v[186:187], v[58:59]
    v_pk_mul_f32 v[188:189], v[188:189], v[60:61]
    v_pk_mul_f32 v[190:191], v[190:191], v[62:63]
    v_cvt_pk_bf16_f32 v84, v184, v185
    v_cvt_pk_bf16_f32 v85, v186, v187
    v_cvt_pk_bf16_f32 v86, v188, v189
    v_cvt_pk_bf16_f32 v87, v190, v191
    buffer_load_dword v74, v246, s[8:11], s36 offen offset:1280
    buffer_load_dword v106, v246, s[8:11], s36 offen offset:1408
    buffer_load_dword v11, v246, s[8:11], s36 offen offset:1536
    buffer_load_dword v43, v246, s[8:11], s36 offen offset:1664
    buffer_load_dword v75, v246, s[8:11], s36 offen offset:1792
    buffer_load_dword v107, v246, s[8:11], s36 offen offset:1920
    buffer_load_dword v12, v246, s[8:11], s37 offen offset:0
    v_pk_mul_f32 v[48:49], v[192:193], s[52:53]
    v_pk_mul_f32 v[50:51], v[194:195], s[52:53]
    v_pk_mul_f32 v[52:53], v[196:197], s[52:53]
    v_pk_mul_f32 v[54:55], v[198:199], s[52:53]
    v_exp_f32 v48, v48
    v_exp_f32 v49, v49
    v_exp_f32 v50, v50
    v_exp_f32 v51, v51
    v_exp_f32 v52, v52
    v_exp_f32 v53, v53
    v_exp_f32 v54, v54
    v_exp_f32 v55, v55
    v_add_f32 v48, 1.0, v48
    v_add_f32 v49, 1.0, v49
    v_add_f32 v50, 1.0, v50
    v_add_f32 v51, 1.0, v51
    v_add_f32 v52, 1.0, v52
    v_add_f32 v53, 1.0, v53
    v_add_f32 v54, 1.0, v54
    v_add_f32 v55, 1.0, v55
    v_rcp_f32 v48, v48
    v_rcp_f32 v49, v49
    v_rcp_f32 v50, v50
    v_rcp_f32 v51, v51
    v_rcp_f32 v52, v52
    v_rcp_f32 v53, v53
    v_rcp_f32 v54, v54
    v_rcp_f32 v55, v55
    v_pk_mul_f32 v[192:193], v[192:193], v[48:49]
    v_pk_mul_f32 v[194:195], v[194:195], v[50:51]
    v_pk_mul_f32 v[196:197], v[196:197], v[52:53]
    v_pk_mul_f32 v[198:199], v[198:199], v[54:55]
    v_cvt_pk_bf16_f32 v88, v192, v193
    v_cvt_pk_bf16_f32 v89, v194, v195
    v_cvt_pk_bf16_f32 v90, v196, v197
    v_cvt_pk_bf16_f32 v91, v198, v199
    buffer_load_dword v44, v246, s[8:11], s37 offen offset:128
    buffer_load_dword v76, v246, s[8:11], s37 offen offset:256
    buffer_load_dword v108, v246, s[8:11], s37 offen offset:384
    v_pk_mul_f32 v[56:57], v[200:201], s[52:53]
    v_pk_mul_f32 v[58:59], v[202:203], s[52:53]
    v_pk_mul_f32 v[60:61], v[204:205], s[52:53]
    v_pk_mul_f32 v[62:63], v[206:207], s[52:53]
    v_exp_f32 v56, v56
    v_exp_f32 v57, v57
    v_exp_f32 v58, v58
    v_exp_f32 v59, v59
    v_exp_f32 v60, v60
    v_exp_f32 v61, v61
    v_exp_f32 v62, v62
    v_exp_f32 v63, v63
    v_add_f32 v56, 1.0, v56
    v_add_f32 v57, 1.0, v57
    v_add_f32 v58, 1.0, v58
    v_add_f32 v59, 1.0, v59
    v_add_f32 v60, 1.0, v60
    v_add_f32 v61, 1.0, v61
    v_add_f32 v62, 1.0, v62
    v_add_f32 v63, 1.0, v63
    v_rcp_f32 v56, v56
    v_rcp_f32 v57, v57
    v_rcp_f32 v58, v58
    v_rcp_f32 v59, v59
    v_rcp_f32 v60, v60
    v_rcp_f32 v61, v61
    v_rcp_f32 v62, v62
    v_rcp_f32 v63, v63
    v_pk_mul_f32 v[200:201], v[200:201], v[56:57]
    v_pk_mul_f32 v[202:203], v[202:203], v[58:59]
    v_pk_mul_f32 v[204:205], v[204:205], v[60:61]
    v_pk_mul_f32 v[206:207], v[206:207], v[62:63]
    v_cvt_pk_bf16_f32 v92, v200, v201
    v_cvt_pk_bf16_f32 v93, v202, v203
    v_cvt_pk_bf16_f32 v94, v204, v205
    v_cvt_pk_bf16_f32 v95, v206, v207
    ds_write_b128 v116, v[80:83] offset:4096
    ds_write_b128 v117, v[84:87] offset:4096
    ds_write_b128 v118, v[88:91] offset:4096
    ds_write_b128 v119, v[92:95] offset:4096
    ds_read_b128 v[16:19], v251 offset:4096
    ds_read_b128 v[20:23], v251 offset:5120
    ds_read_b128 v[24:27], v251 offset:6144
    ds_read_b128 v[28:31], v251 offset:7168
    s_lshl_b32 s68, s50, 7
    s_waitcnt lgkmcnt(0)
    buffer_store_dwordx4 v[16:19], v120, s[76:79], s68 offen offset:0 sc1
    buffer_store_dwordx4 v[20:23], v121, s[76:79], s68 offen offset:1024 sc1
    buffer_store_dwordx4 v[24:27], v120, s[76:79], s68 offen offset:2048 sc1
    s_mov_b64 exec, 0xff
    buffer_store_dwordx4 v[28:31], v121, s[76:79], s68 offen offset:3072 sc1
    s_mov_b64 exec, -1
    v_mul_u32_u24 v251, 192, v249
    v_add_u32 v251, v251, v248
    s_lshr_b32 s68, s25, 2
    s_lshl_b32 s68, s68, 7
    s_and_b32 s69, s25, 1
    s_mul_i32 s69, s69, 12288
    s_add_u32 s68, s68, s69
    s_bfe_u32 s69, s25, 0x10001
    s_mul_i32 s69, s69, 384
    s_add_u32 s68, s68, s69
    s_add_u32 s69, s68, 6144
    buffer_load_dword v128, v251, s[88:91], s68 offen offset:0
    buffer_load_dword v129, v251, s[88:91], s68 offen offset:768
    buffer_load_dword v130, v251, s[88:91], s68 offen offset:1536
    buffer_load_dword v131, v251, s[88:91], s68 offen offset:2304
    buffer_load_dword v132, v251, s[88:91], s69 offen offset:0
    buffer_load_dword v133, v251, s[88:91], s69 offen offset:768
    buffer_load_dword v134, v251, s[88:91], s69 offen offset:1536
    buffer_load_dword v135, v251, s[88:91], s69 offen offset:2304
    s_add_u32 s70, s25, 8
    s_lshr_b32 s68, s70, 2
    s_lshl_b32 s68, s68, 7
    s_and_b32 s69, s70, 1
    s_mul_i32 s69, s69, 12288
    s_add_u32 s68, s68, s69
    s_bfe_u32 s69, s70, 0x10001
    s_mul_i32 s69, s69, 384
    s_add_u32 s68, s68, s69
    s_cmp_lt_u32 s25, 4
    s_cselect_b32 s68, s68, 0x10000
    s_add_u32 s69, s68, 6144
    buffer_load_dword v136, v251, s[88:91], s68 offen offset:0
    buffer_load_dword v137, v251, s[88:91], s68 offen offset:768
    buffer_load_dword v138, v251, s[88:91], s68 offen offset:1536
    buffer_load_dword v139, v251, s[88:91], s68 offen offset:2304
    buffer_load_dword v140, v251, s[88:91], s69 offen offset:0
    buffer_load_dword v141, v251, s[88:91], s69 offen offset:768
    buffer_load_dword v142, v251, s[88:91], s69 offen offset:1536
    buffer_load_dword v143, v251, s[88:91], s69 offen offset:2304
    v_mul_u32_u24 v251, 48, v249
    v_add_u32 v251, v251, v248
    s_sub_u32 s68, s25, 4
    s_lshl_b32 s68, s68, 7
    s_cmp_lt_u32 s25, 4
    s_cselect_b32 s68, 0x10000, s68
    buffer_load_dword v174, v251, s[92:95], s68 offen
    buffer_load_dword v175, v251, s[92:95], s68 offen offset:384
    s_waitcnt vmcnt(0)
    s_barrier
    s_cmp_lg_u32 s25, 0
    s_cbranch_scc1 F_nostat2
    v_mov_b32 v176, 0
    v_or_b32 v160, s44, v176
    v_mov_b32 v161, s45
    v_mov_b32 v162, s46
    v_mov_b32 v163, s47
    v_mov_b32 v164, 0
    s_lshl_b32 s68, s49, 4
    s_add_u32 s68, s68, 2097408
    s_mov_b64 exec, 1
    buffer_store_dwordx4 v[160:163], v164, s[16:19], s68 offen sc1
    s_mov_b64 exec, -1
F_nostat2:
    v_lshlrev_b32 v125, 5, v247
    s_lshl_b32 s75, s50, 9
    s_mov_b64 exec, 0x1ffffff
    buffer_load_dword v124, v125, s[8:11], s75 offen offset:128
    s_mov_b64 exec, -1
    s_mov_b32 s72, 0x05040100
    s_mov_b32 s73, 0x07060302
    v_perm_b32 v144, v129, v128, s72
    v_perm_b32 v145, v131, v130, s72
    v_perm_b32 v146, v133, v132, s72
    v_perm_b32 v147, v135, v134, s72
    v_perm_b32 v148, v129, v128, s73
    v_perm_b32 v149, v131, v130, s73
    v_perm_b32 v150, v133, v132, s73
    v_perm_b32 v151, v135, v134, s73
    s_lshr_b32 s68, s25, 2
    s_lshl_b32 s68, s68, 13
    s_and_b32 s69, s25, 3
    s_lshl_b32 s69, s69, 10
    s_add_u32 s68, s68, s69
    v_add_u32 v251, s68, v247
    ds_write_b128 v251, v[144:147]
    ds_write_b128 v251, v[148:151] offset:4096
    s_cmp_ge_u32 s25, 4
    s_cbranch_scc1 F_swf2
    s_add_u32 s70, s25, 8
    v_perm_b32 v144, v137, v136, s72
    v_perm_b32 v145, v139, v138, s72
    v_perm_b32 v146, v141, v140, s72
    v_perm_b32 v147, v143, v142, s72
    v_perm_b32 v148, v137, v136, s73
    v_perm_b32 v149, v139, v138, s73
    v_perm_b32 v150, v141, v140, s73
    v_perm_b32 v151, v143, v142, s73
    s_lshr_b32 s68, s70, 2
    s_lshl_b32 s68, s68, 13
    s_and_b32 s69, s70, 3
    s_lshl_b32 s69, s69, 10
    s_add_u32 s68, s68, s69
    v_add_u32 v251, s68, v247
    ds_write_b128 v251, v[144:147]
    ds_write_b128 v251, v[148:151] offset:4096
    s_branch F_swf3
F_swf2:
    s_cmp_ge_u32 s25, 7
    s_cbranch_scc1 F_swf3
    v_perm_b32 v144, v175, v174, s72
    v_perm_b32 v146, v175, v174, s73
    v_mov_b32 v145, 0
    v_mov_b32 v147, 0
    s_lshl_b32 s68, s25, 11
    s_add_u32 s68, s68, 16384
    v_add_u32 v251, s68, v247
    ds_write_b64 v251, v[144:145]
    ds_write_b64 v251, v[146:147] offset:1024
F_swf3:
    v_mov_b32 v172, 0
    v_mov_b32 v173, 0
    v_mov_b32 v174, 0
    v_mov_b32 v175, 0
    v_add_u32 v170, s29, v247
    ds_write_b128 v170, v[172:175]
    ds_write_b128 v170, v[172:175] offset:640
    v_mov_b32 v170, 44032
    ds_write_b128 v170, v[172:175]
    ds_write_b128 v170, v[172:175] offset:16
    ds_write_b128 v170, v[172:175] offset:32
    s_mov_b32 s50, 1
F_joined:
    s_lshl_b32 s68, s25, 6
    v_lshrrev_b32 v160, 4, v247
    v_add_u32 v160, s68, v160
    v_lshrrev_b32 v161, 2, v160
    v_and_b32 v162, 3, v160
    v_lshlrev_b32 v162, 4, v162
    v_lshl_add_u32 v161, v161, 14, v162
    v_lshlrev_b32 v162, 4, v160
    s_lshl_b32 s70, s24, 6
    s_add_u32 s70, s70, 256
    s_mov_b32 s71, 2097408
    s_mov_b64 s[52:53], -1
    s_cmp_lt_u32 s25, 4
    s_cselect_b64 s[54:55], -1, 0
    v_mov_b32 v180, 0
    v_lshl_add_u32 v254, v249, 7, v248
    s_movk_i32 s84, 3200
    s_movk_i32 s85, 2176
    s_movk_i32 s86, 1152
    s_movk_i32 s87, 128
    s_movk_i32 s88, 3328
    s_movk_i32 s89, 2304
    s_movk_i32 s90, 1280
    s_movk_i32 s91, 256
    s_movk_i32 s92, 3456
    s_movk_i32 s93, 2432
    s_movk_i32 s94, 1408
    s_movk_i32 s95, 384
    s_add_u32 s76, s16, 5317888
    s_addc_u32 s77, s17, 0
    s_mov_b32 s78, 6400000
    s_mov_b32 s79, 0x20000
    s_mul_i32 s68, s26, 6
    s_and_b32 s68, s68, -4
    s_sub_u32 s49, s27, s68
    s_mov_b32 m0, s27
    v_lshrrev_b32 v200, 2, v247
    buffer_load_dword v200, s[12:15], s68 offen lds
    s_waitcnt vmcnt(1)
    v_and_b32 v16, s33, v0
    v_lshlrev_b32 v0, 16, v0
    v_and_b32 v48, s33, v32
    v_lshlrev_b32 v32, 16, v32
    v_and_b32 v80, s33, v64
    v_lshlrev_b32 v64, 16, v64
    v_and_b32 v112, s33, v96
    v_lshlrev_b32 v96, 16, v96
    v_and_b32 v17, s33, v1
    v_lshlrev_b32 v1, 16, v1
    v_and_b32 v49, s33, v33
    v_lshlrev_b32 v33, 16, v33
    v_and_b32 v81, s33, v65
    v_lshlrev_b32 v65, 16, v65
    v_and_b32 v113, s33, v97
    v_lshlrev_b32 v97, 16, v97
    v_and_b32 v18, s33, v2
    v_lshlrev_b32 v2, 16, v2
    v_and_b32 v50, s33, v34
    v_lshlrev_b32 v34, 16, v34
    v_and_b32 v82, s33, v66
    v_lshlrev_b32 v66, 16, v66
    v_and_b32 v114, s33, v98
    v_lshlrev_b32 v98, 16, v98
    v_and_b32 v19, s33, v3
    v_lshlrev_b32 v3, 16, v3
    v_and_b32 v51, s33, v35
    v_lshlrev_b32 v35, 16, v35
    v_and_b32 v83, s33, v67
    v_lshlrev_b32 v67, 16, v67
    v_and_b32 v115, s33, v99
    v_lshlrev_b32 v99, 16, v99
    v_and_b32 v20, s33, v4
    v_lshlrev_b32 v4, 16, v4
    v_and_b32 v52, s33, v36
    v_lshlrev_b32 v36, 16, v36
    v_and_b32 v84, s33, v68
    v_lshlrev_b32 v68, 16, v68
    v_and_b32 v116, s33, v100
    v_lshlrev_b32 v100, 16, v100
    v_and_b32 v21, s33, v5
    v_lshlrev_b32 v5, 16, v5
    v_and_b32 v53, s33, v37
    v_lshlrev_b32 v37, 16, v37
    v_and_b32 v85, s33, v69
    v_lshlrev_b32 v69, 16, v69
    v_and_b32 v117, s33, v101
    v_lshlrev_b32 v101, 16, v101
    v_and_b32 v22, s33, v6
    v_lshlrev_b32 v6, 16, v6
    v_and_b32 v54, s33, v38
    v_lshlrev_b32 v38, 16, v38
    v_and_b32 v86, s33, v70
    v_lshlrev_b32 v70, 16, v70
    v_and_b32 v118, s33, v102
    v_lshlrev_b32 v102, 16, v102
    v_and_b32 v23, s33, v7
    v_lshlrev_b32 v7, 16, v7
    v_and_b32 v55, s33, v39
    v_lshlrev_b32 v39, 16, v39
    v_and_b32 v87, s33, v71
    v_lshlrev_b32 v71, 16, v71
    v_and_b32 v119, s33, v103
    v_lshlrev_b32 v103, 16, v103
    v_and_b32 v24, s33, v8
    v_lshlrev_b32 v8, 16, v8
    v_and_b32 v56, s33, v40
    v_lshlrev_b32 v40, 16, v40
    v_and_b32 v88, s33, v72
    v_lshlrev_b32 v72, 16, v72
    v_and_b32 v120, s33, v104
    v_lshlrev_b32 v104, 16, v104
    v_and_b32 v25, s33, v9
    v_lshlrev_b32 v9, 16, v9
    v_and_b32 v57, s33, v41
    v_lshlrev_b32 v41, 16, v41
    v_and_b32 v89, s33, v73
    v_lshlrev_b32 v73, 16, v73
    v_and_b32 v121, s33, v105
    v_lshlrev_b32 v105, 16, v105
    v_and_b32 v26, s33, v10
    v_lshlrev_b32 v10, 16, v10
    v_and_b32 v58, s33, v42
    v_lshlrev_b32 v42, 16, v42
    v_and_b32 v90, s33, v74
    v_lshlrev_b32 v74, 16, v74
    v_and_b32 v122, s33, v106
    v_lshlrev_b32 v106, 16, v106
    v_and_b32 v27, s33, v11
    v_lshlrev_b32 v11, 16, v11
    v_and_b32 v59, s33, v43
    v_lshlrev_b32 v43, 16, v43
    v_and_b32 v91, s33, v75
    v_lshlrev_b32 v75, 16, v75
    v_and_b32 v123, s33, v107
    v_lshlrev_b32 v107, 16, v107
    v_and_b32 v28, s33, v12
    v_lshlrev_b32 v12, 16, v12
    v_and_b32 v60, s33, v44
    v_lshlrev_b32 v44, 16, v44
    v_and_b32 v92, s33, v76
    v_lshlrev_b32 v76, 16, v76
    v_and_b32 v124, s33, v108
    v_lshlrev_b32 v108, 16, v108
    s_mov_b32 s72, 0x0c0c0703
    s_mov_b32 s73, 0x07030c0c
    s_mov_b32 s74, 0x40000
    s_cmp_eq_u32 s50, 0
    s_cbranch_scc1 F_pollf
    s_cmp_lg_u32 s25, 0
    s_cbranch_scc1 F_pollf
    s_lshl_b32 s32, s32, 3
    s_add_u32 s32, s32, 4096
    v_mov_b32 v163, s32
    s_mov_b64 s[56:57], 1
F_polls:
    s_mov_b64 exec, s[56:57]
    buffer_load_dwordx4 v[196:199], v163, s[16:19], s71 offen sc1
    s_mov_b64 exec, -1
    s_waitcnt vmcnt(0)
    v_perm_b32 v192, v197, v196, s72
    v_perm_b32 v193, v199, v198, s73
    v_or_b32 v192, v192, v193
    v_cmp_ne_u32 vcc, s51, v192
    s_nop 0
    s_and_b64 s[56:57], s[56:57], vcc
    s_cbranch_scc0 F_pollf
    s_sub_u32 s74, s74, 1
    s_cbranch_scc0 F_polls
F_pollf:
    s_waitcnt lgkmcnt(0)
    s_barrier
F_poll:
    s_mov_b64 exec, s[52:53]
    buffer_load_dwordx4 v[176:179], v161, s[16:19], s70 offen sc1
    s_mov_b64 exec, -1
    s_mov_b64 exec, s[54:55]
    buffer_load_dwordx4 v[180:183], v162, s[16:19], s71 offen sc1
    s_mov_b64 exec, -1
    s_waitcnt vmcnt(0)
    v_perm_b32 v192, v177, v176, s72
    v_perm_b32 v193, v179, v178, s73
    v_or_b32 v192, v192, v193
    v_cmp_ne_u32 vcc, s51, v192
    s_nop 0
    s_and_b64 s[52:53], s[52:53], vcc
    v_perm_b32 v192, v181, v180, s72
    v_perm_b32 v193, v183, v182, s73
    v_or_b32 v192, v192, v193
    v_cmp_ne_u32 vcc, s51, v192
    s_nop 0
    s_and_b64 s[54:55], s[54:55], vcc
    s_or_b64 vcc, s[52:53], s[54:55]
    s_cbranch_scc0 F_polled
    s_sub_u32 s74, s74, 1
    s_cbranch_scc0 F_poll
F_polled:
    s_waitcnt vmcnt(0)
    s_lshl_b32 s44, s96, 16
    s_and_b32 s45, s96, s33
    s_lshl_b32 s46, s97, 16
    s_and_b32 s47, s97, s33
    v_and_b32 v180, 0xffffff, v180
    v_cmp_lt_u32 vcc, 0, v180
    s_nop 0
    s_and_b64 vcc, vcc, exec
    s_cbranch_scc0 F_noflag
    s_sub_u32 s68, 255, s24
    v_and_b32 v181, 0xffffff, v181
    v_and_b32 v182, 0xffffff, v182
    v_mov_b32 v183, -1
    v_mul_u32_u24 v193, 3125, v162
    v_lshrrev_b32 v193, 1, v193
    s_mov_b32 s69, 2117888
    s_mov_b64 exec, vcc
    v_cmp_le_u32 vcc, s68, v181
    s_nop 0
    s_mov_b64 exec, vcc
    v_cmp_le_u32 vcc, s24, v182
    s_nop 0
    s_mov_b64 exec, vcc
    v_mov_b32 v192, 44064
    ds_max_u32 v192, v180
    buffer_load_dword v183, v193, s[16:19], s69 offen sc1
    s_mov_b64 exec, -1
    s_waitcnt vmcnt(0)
    v_mov_b32 v175, 1
    s_movk_i32 s68, 2675
    s_movk_i32 s69, 196
    s_mov_b32 s70, 44032
    s_lshl_b32 s71, s41, 16
    v_lshrrev_b32 v192, 16, v183
    v_subrev_u32 v192, s41, v192
    v_cmp_gt_u32 s[52:53], s69, v192
    v_mul_u32_u24 v192, s68, v192
    v_lshrrev_b32 v192, 16, v192
    v_lshl_add_u32 v200, v192, 2, s70
    s_mov_b64 exec, s[52:53]
    ds_add_rtn_u32 v200, v200, v175
    s_mov_b64 exec, -1
    v_mov_b32 v175, 142464
    s_movk_i32 s69, 128
    s_movk_i32 s68, 2560
    v_mad_u32_u24 v192, v192, s68, v175
    s_waitcnt lgkmcnt(0)
    v_lshl_add_u32 v192, v200, 2, v192
    s_mov_b64 exec, s[52:53]
    v_cmp_gt_u32 vcc, s69, v200
    s_nop 0
    s_mov_b64 exec, vcc
    ds_write_b32 v192, v183
    s_mov_b64 exec, -1
F_noflag:
    v_mov_b32 v175, 1
    s_movk_i32 s68, 2675
    s_movk_i32 s69, 196
    s_mov_b32 s70, 44032
    s_lshl_b32 s71, s41, 16
    v_bfe_u32 v192, v176, 16, 8
    v_and_b32 v176, 0xffffff, v176
    v_add_u32 v176, s71, v176
    v_cmp_gt_u32 s[52:53], s69, v192
    v_mul_u32_u24 v192, s68, v192
    v_lshrrev_b32 v192, 16, v192
    v_lshl_add_u32 v200, v192, 2, s70
    v_bfe_u32 v193, v177, 16, 8
    v_and_b32 v177, 0xffffff, v177
    v_add_u32 v177, s71, v177
    v_cmp_gt_u32 s[54:55], s69, v193
    v_mul_u32_u24 v193, s68, v193
    v_lshrrev_b32 v193, 16, v193
    v_lshl_add_u32 v201, v193, 2, s70
    v_bfe_u32 v194, v178, 16, 8
    v_and_b32 v178, 0xffffff, v178
    v_add_u32 v178, s71, v178
    v_cmp_gt_u32 s[56:57], s69, v194
    v_mul_u32_u24 v194, s68, v194
    v_lshrrev_b32 v194, 16, v194
    v_lshl_add_u32 v202, v194, 2, s70
    v_bfe_u32 v195, v179, 16, 8
    v_and_b32 v179, 0xffffff, v179
    v_add_u32 v179, s71, v179
    v_cmp_gt_u32 s[58:59], s69, v195
    v_mul_u32_u24 v195, s68, v195
    v_lshrrev_b32 v195, 16, v195
    v_lshl_add_u32 v203, v195, 2, s70
    s_mov_b64 exec, s[52:53]
    ds_add_rtn_u32 v200, v200, v175
    s_mov_b64 exec, s[54:55]
    ds_add_rtn_u32 v201, v201, v175
    s_mov_b64 exec, s[56:57]
    ds_add_rtn_u32 v202, v202, v175
    s_mov_b64 exec, s[58:59]
    ds_add_rtn_u32 v203, v203, v175
    s_mov_b64 exec, -1
    v_mov_b32 v175, 142464
    s_movk_i32 s69, 128
    s_movk_i32 s68, 2560
    v_mad_u32_u24 v192, v192, s68, v175
    v_mad_u32_u24 v193, v193, s68, v175
    v_mad_u32_u24 v194, v194, s68, v175
    v_mad_u32_u24 v195, v195, s68, v175
    s_waitcnt lgkmcnt(1)
    v_lshl_add_u32 v192, v200, 2, v192
    s_mov_b64 exec, s[52:53]
    v_cmp_gt_u32 vcc, s69, v200
    s_nop 0
    s_mov_b64 exec, vcc
    ds_write_b32 v192, v176
    s_mov_b64 exec, -1
    v_lshl_add_u32 v193, v201, 2, v193
    s_mov_b64 exec, s[54:55]
    v_cmp_gt_u32 vcc, s69, v201
    s_nop 0
    s_mov_b64 exec, vcc
    ds_write_b32 v193, v177
    s_mov_b64 exec, -1
    v_lshl_add_u32 v194, v202, 2, v194
    s_mov_b64 exec, s[56:57]
    v_cmp_gt_u32 vcc, s69, v202
    s_nop 0
    s_mov_b64 exec, vcc
    ds_write_b32 v194, v178
    s_mov_b64 exec, -1
    s_waitcnt lgkmcnt(3)
    v_lshl_add_u32 v195, v203, 2, v195
    s_mov_b64 exec, s[58:59]
    v_cmp_gt_u32 vcc, s69, v203
    s_nop 0
    s_mov_b64 exec, vcc
    ds_write_b32 v195, v179
    s_mov_b64 exec, -1
    s_mov_b32 s63, 0
    s_waitcnt lgkmcnt(0)
    s_barrier
    s_or_b32 s68, s2, s25
    s_cbranch_scc1 F_noepoch
    v_mov_b32 v192, s48
    v_mov_b32 v193, 0
    s_mov_b64 exec, 1
    buffer_store_dword v192, v193, s[16:19], 0 offen sc1
    s_mov_b64 exec, -1
F_noepoch:
    s_lshl_b32 s68, s25, 2
    s_add_u32 s68, s68, 44032
    v_mov_b32 v192, s68
    ds_read_b32 v193, v192
    s_mul_i32 s28, s25, 2560
    s_add_u32 s28, s28, 142464
    v_lshrrev_b32 v170, 4, v247
    v_lshl_add_u32 v192, v170, 2, s28
    ds_read2st64_b32 v[160:161], v192 offset0:0 offset1:1
    v_mov_b32 v194, 44032
    ds_read_b128 v[196:199], v194
    ds_read_b128 v[200:203], v194 offset:16
    ds_read_b32 v204, v194 offset:32
    s_waitcnt lgkmcnt(0)
    v_max3_u32 v196, v196, v197, v198
    v_max3_u32 v196, v196, v199, v200
    v_max3_u32 v196, v196, v201, v202
    v_max_u32 v196, v196, v203
    v_readfirstlane_b32 s32, v204
    v_readfirstlane_b32 s68, v196
    s_min_u32 s32, s32, 6250
    s_add_u32 s32, s32, 16
    s_mov_b32 s31, 17
    s_cmp_gt_u32 s68, 128
    s_cbranch_scc0 F_fast
    s_mov_b32 s31, 0
    s_branch F_round
F_fast:
F_prep:
    s_mov_b32 s67, 0
    s_bitcmp0_b32 s25, 0
    s_cselect_b64 s[64:65], s[42:43], 0
    s_setprio 3
    s_add_u32 s50, s28, 512
    v_add_u32 v194, 64, v170
    v_cmp_gt_u32 vcc, v193, v170
    v_cmp_gt_u32 s[52:53], v193, v194
    v_readfirstlane_b32 s30, v193
    v_cndmask_b32 v160, -1, v160, vcc
    v_cndmask_b32 v161, -1, v161, s[52:53]
    v_and_b32 v192, 0xffff, v160
    v_lshrrev_b32 v193, 16, v160
    v_mul_u32_u24 v192, 6, v192
    v_mul_u32_u24 v193, 6, v193
    v_and_b32 v192, -4, v192
    s_mov_b64 exec, vcc
    buffer_load_dwordx2 v[162:163], v192, s[12:15], 0 offen
    s_mov_b64 exec, -1
    v_and_b32 v193, -4, v193
    v_add_u32 v193, s49, v193
    v_and_b32 v192, 0xffff, v161
    v_lshrrev_b32 v194, 16, v161
    v_mul_u32_u24 v192, 6, v192
    v_mul_u32_u24 v194, 6, v194
    v_and_b32 v192, -4, v192
    s_mov_b64 exec, s[52:53]
    buffer_load_dwordx2 v[166:167], v192, s[12:15], 0 offen
    s_mov_b64 exec, -1
    v_and_b32 v194, -4, v194
    v_add_u32 v194, s49, v194
    ds_read2_b32 v[164:165], v193 offset0:0 offset1:1
    ds_read2_b32 v[168:169], v194 offset0:0 offset1:1
    s_mov_b32 s69, 0
    s_mov_b32 s71, 0
    s_mov_b32 s72, 0x05040100
    s_waitcnt vmcnt(1)
    s_waitcnt lgkmcnt(0)
F_pass:
    v_lshlrev_b32 v176, 4, v160
    v_lshrrev_b32 v185, 12, v160
    v_and_b32 v176, 16, v176
    v_and_b32 v185, 16, v185
    v_alignbit_b32 v177, v163, v162, v176
    v_alignbit_b32 v179, v165, v164, v185
    v_lshrrev_b32 v178, v176, v163
    v_lshrrev_b32 v180, v185, v165
    v_lshlrev_b32 v181, 16, v177
    v_and_b32 v177, s33, v177
    v_lshlrev_b32 v178, 16, v178
    v_lshlrev_b32 v182, 16, v179
    v_and_b32 v179, s33, v179
    v_lshlrev_b32 v180, 16, v180
    v_sub_f32 v181, v181, v182
    v_sub_f32 v177, v177, v179
    v_sub_f32 v178, v178, v180
    v_cvt_pk_bf16_f32 v182, v181, v177
    v_cvt_pk_bf16_f32 v179, v178, v178
    v_lshlrev_b32 v181, 16, v182
    v_and_b32 v177, s33, v182
    v_and_b32 v178, s33, v179
    v_mul_f32 v182, v181, v181
    v_mul_f32 v179, v177, v177
    v_mul_f32 v180, v178, v178
    v_cvt_pk_bf16_f32 v182, v182, v179
    v_cvt_pk_bf16_f32 v180, v180, v180
    v_lshlrev_b32 v179, 16, v182
    v_and_b32 v182, s33, v182
    v_and_b32 v180, s33, v180
    v_add_f32 v179, v179, v182
    v_add_f32 v179, v179, v180
    v_cvt_pk_bf16_f32 v179, v179, v179
    v_and_b32 v179, s33, v179
    v_add_f32 v179, 0x322bcc77, v179
    v_cvt_pk_bf16_f32 v179, v179, v179
    v_and_b32 v179, s33, v179
    v_sqrt_f32 v179, v179
    v_lshrrev_b32 v185, 16, v160
    v_cvt_pk_bf16_f32 v179, v179, v179
    v_and_b32 v179, s33, v179
    v_mul_f32 v184, 0x40490fdb, v179
    v_subrev_u32 v185, s26, v185
    v_cvt_pk_bf16_f32 v184, v184, v184
    v_and_b32 v184, s33, v184
    v_mul_f32 v184, 0x3e4ccccd, v184
    v_lshlrev_b32 v188, 2, v185
    v_cvt_pk_bf16_f32 v184, v184, v184
    v_and_b32 v184, s33, v184
    v_mul_f32 v184, 0.15915494, v184
    v_and_b32 v188, 0x30, v188
    v_cos_f32 v184, v184
    v_cmp_gt_f32 vcc, 0x40a00000, v179
    v_cmp_ne_u32 s[52:53], -1, v160
    v_cvt_pk_bf16_f32 v184, v184, v184
    v_and_b32 v184, s33, v184
    v_add_f32 v184, 1.0, v184
    s_and_b64 s[52:53], s[52:53], vcc
    v_cvt_pk_bf16_f32 v184, v184, v184
    v_and_b32 v184, s33, v184
    v_rcp_f32 v180, v179
    v_cmp_neq_f32 vcc, 0, v184
    v_mul_f32 v184, 0.5, v184
    s_and_b64 s[52:53], vcc, s[52:53]
    v_mbcnt_lo_u32_b32 v171, s52, 0
    v_mbcnt_hi_u32_b32 v171, s53, v171
    s_bcnt1_i32_b64 s68, s[52:53]
    v_add_u32 v171, s69, v171
    s_add_u32 s69, s69, s68
    v_lshlrev_b32 v176, 1, v171
    v_xor_b32 v189, v171, v176
    v_add_u32 v190, s69, v170
    v_and_b32 v189, 8, v189
    v_lshl_or_b32 v189, v189, 1, v189
    v_cmp_gt_u32 s[54:55], s38, v190
    v_xor_b32 v176, v176, v189
    v_xor_b32 v176, v176, v188
    v_and_b32 v176, 0x3f, v176
    v_lshl_add_u32 v176, v185, 6, v176
    v_lshl_add_u32 v188, v171, 2, s28
    v_perm_b32 v176, v176, v160, s72
    v_lshl_add_u32 v189, v190, 2, s28
    v_mov_b32 v185, 104923135
    s_mov_b64 exec, s[52:53]
    ds_write_b32 v188, v176
    s_mov_b64 exec, s[54:55]
    ds_write_b32 v189, v185
    s_mov_b64 exec, -1
    s_cmp_lg_u32 s71, 0
    s_cbranch_scc0 F_pass_ld
    s_cmp_ge_u32 s70, 32
    s_cbranch_scc1 F_pass_b
    s_waitcnt vmcnt(0)
F_pass_ld:
    v_add_u32 v246, s28, v248
    ds_read_b32 v246, v246
    v_add_u32_sdwa v172, s28, v210 dst_sel:DWORD dst_unused:UNUSED_PAD src0_sel:DWORD src1_sel:BYTE_3
    ds_read_b128 v[172:175], v172 offset:0
    s_waitcnt lgkmcnt(0)
    v_mad_u32_u16 v172, v172, s38, v243
    v_mad_u32_u16 v173, v173, s38, v243
    v_mad_u32_u16 v174, v174, s38, v243
    v_mad_u32_u16 v175, v175, s38, v243
    buffer_load_dwordx4 v[128:131], v172, s[76:79], 0 offen sc1
    buffer_load_dwordx4 v[132:135], v173, s[76:79], 0 offen sc1
    buffer_load_dwordx4 v[136:139], v174, s[76:79], 0 offen sc1
    buffer_load_dwordx4 v[140:143], v175, s[76:79], 0 offen sc1
F_pass_b:
    v_mul_f32 v182, s44, v179
    v_mul_f32 v183, s45, v179
    v_mul_f32 v186, s46, v179
    v_mul_f32 v187, s47, v179
    v_cvt_pk_bf16_f32 v182, v182, v183
    v_cvt_pk_bf16_f32 v186, v186, v187
    v_mul_f32 v181, v181, v180
    v_and_b32 v183, s33, v182
    v_lshlrev_b32 v182, 16, v182
    v_and_b32 v187, s33, v186
    v_lshlrev_b32 v186, 16, v186
    v_mul_f32 v182, 0.15915494, v182
    v_mul_f32 v183, 0.15915494, v183
    v_mul_f32 v186, 0.15915494, v186
    v_mul_f32 v187, 0.15915494, v187
    v_fract_f32 v182, v182
    v_fract_f32 v183, v183
    v_fract_f32 v186, v186
    v_fract_f32 v187, v187
    v_sin_f32 v182, v182
    v_sin_f32 v183, v183
    v_sin_f32 v186, v186
    v_sin_f32 v187, v187
    v_mul_f32 v177, v177, v180
    v_mul_f32 v178, v178, v180
    v_cvt_pk_bf16_f32 v182, v182, v183
    v_cvt_pk_bf16_f32 v186, v186, v187
    v_cvt_pk_bf16_f32 v188, v181, v177
    v_cvt_pk_bf16_f32 v189, v178, v178
    v_and_b32 v183, s33, v182
    v_lshlrev_b32 v182, 16, v182
    v_and_b32 v187, s33, v186
    v_lshlrev_b32 v186, 16, v186
    v_lshlrev_b32 v181, 16, v188
    v_and_b32 v177, s33, v188
    v_and_b32 v178, s33, v189
    v_mul_f32 v182, v182, v180
    v_mul_f32 v183, v183, v180
    v_mul_f32 v186, v186, v180
    v_mul_f32 v187, v187, v180
    v_mul_f32 v181, v184, v181
    v_mul_f32 v177, v184, v177
    v_mul_f32 v178, v184, v178
    v_cvt_pk_bf16_f32 v182, v182, v183
    v_cvt_pk_bf16_f32 v183, v186, v187
    v_cvt_pk_bf16_f32 v186, v184, v181
    v_cvt_pk_bf16_f32 v187, v177, v178
    v_lshl_add_u32 v178, v171, 3, s50
    v_lshl_add_u32 v177, v190, 3, s50
    v_mov_b32 v180, 0
    v_mov_b32 v181, 0
    s_mov_b64 exec, s[52:53]
    ds_write_b64 v178, v[182:183]
    ds_write_b64 v178, v[186:187] offset:1024
    s_mov_b64 exec, s[54:55]
    ds_write_b64 v177, v[180:181]
    s_mov_b64 exec, -1
    s_cmp_lg_u32 s71, 0
    s_cbranch_scc1 F_pass_done
    s_cmp_le_u32 s30, 64
    s_cbranch_scc1 F_pass_done
    s_mov_b32 s71, 1
    s_mov_b32 s70, s69
    s_waitcnt vmcnt(4)
    v_mov_b32 v160, v161
    v_mov_b64 v[162:163], v[166:167]
    v_mov_b64 v[164:165], v[168:169]
    s_branch F_pass
F_pass_done:
    s_waitcnt vmcnt(4)
    s_mov_b32 s66, s69
    s_add_u32 s30, s69, 31
    s_lshr_b32 s30, s30, 5
F_tiles:
    s_cmp_eq_u32 s30, 0
    s_cbranch_scc1 F_tiles_done
F_loop:
    s_setprio 0
    s_cmp_lt_u32 s30, 2
    s_cbranch_scc1 F_pr
    s_setprio 1
    s_cmp_lt_u32 s30, 3
    s_cbranch_scc1 F_pr
    s_setprio 2
F_pr:
    ds_read_b128 v[224:227], v247 offset:0
    ds_read_b128 v[228:231], v247 offset:1024
    ds_read_b128 v[232:235], v247 offset:2048
    ds_read_b128 v[236:239], v247 offset:3072
    ds_read_b64 v[240:241], v247 offset:24576
    v_add_u32 v242, s50, v244
    v_lshl_add_u32 v208, v248, 1, s50
    v_add_u32_sdwa v251, s29, v246 dst_sel:DWORD dst_unused:UNUSED_PAD src0_sel:DWORD src1_sel:WORD_1
    s_add_u32 s50, s50, 256
    v_add_u32 v246, s28, v248
    ds_read_b32 v242, v242
    ds_read_b64 v[208:209], v208 offset:1024
    ds_read_b32 v246, v246 offset:128
    v_add_u32_sdwa v183, s28, v210 dst_sel:DWORD dst_unused:UNUSED_PAD src0_sel:DWORD src1_sel:BYTE_3
    v_xor_b32 v177, 16, v245
    v_xor_b32 v178, 32, v245
    v_xor_b32 v179, 48, v245
    s_waitcnt vmcnt(0)
    ds_write_b128 v245, v[128:131] offset:0
    ds_write_b128 v177, v[132:135] offset:1024
    ds_write_b128 v178, v[136:139] offset:2048
    ds_write_b128 v179, v[140:143] offset:3072
    ds_read_b128 v[144:147], v212
    ds_read_b128 v[148:151], v213
    ds_read_b128 v[152:155], v214
    ds_read_b128 v[156:159], v215
    ds_read_b128 v[128:131], v183
    ds_read_b128 v[140:143], v183 offset:128
    s_waitcnt lgkmcnt(2)
    v_mfma_f32_32x32x16_bf16 v[192:207], v[144:147], v[224:227], 0
    s_waitcnt lgkmcnt(1)
    v_mad_u32_u16 v128, v128, s40, v243
    v_mad_u32_u16 v129, v129, s40, v243
    v_mad_u32_u16 v130, v130, s40, v243
    v_mfma_f32_32x32x16_bf16 v[192:207], v[148:151], v[228:231], v[192:207]
    v_mad_u32_u16 v131, v131, s40, v243
    s_add_u32 m0, s27, 0
    v_mfma_f32_32x32x16_bf16 v[192:207], v[152:155], v[232:235], v[192:207]
    buffer_load_dwordx4 v128, s[4:7], s84 offen offset:0 lds
    buffer_load_dwordx4 v129, s[4:7], s85 offen offset:1024 lds
    v_mfma_f32_32x32x16_bf16 v[192:207], v[156:159], v[236:239], v[192:207]
    buffer_load_dwordx4 v130, s[4:7], s86 offen offset:2048 lds
    buffer_load_dwordx4 v131, s[4:7], s87 offen offset:3072 lds
    s_cmp_le_u32 s66, 16
    s_cselect_b64 vcc, -1, 0
    s_sub_u32 s66, s66, 32
    s_cmp_lt_u32 s31, s32
    s_cselect_b32 s67, 0, s30
    v_mfma_f32_32x32x8_bf16 v[176:191], v[242:243], v[240:241], 0
    ds_write_b16 v251, v208
    ds_read_b128 v[216:219], v211
    ds_read_b128 v[220:223], v250
    ds_read_b128 v[224:227], v247 offset:4096
    ds_read_b128 v[228:231], v247 offset:5120
    ds_read_b128 v[232:235], v247 offset:6144
    ds_read_b128 v[236:239], v247 offset:7168
    ds_read_b64 v[240:241], v247 offset:25600
    s_waitcnt lgkmcnt(1)
    v_mfma_f32_32x32x16_bf16 v[160:175], v[144:147], v[224:227], 0
    s_nop 1
    v_mul_f32 v192, v192, v177
    v_mul_f32 v193, v193, v176
    v_mul_f32 v194, v194, v179
    v_mfma_f32_32x32x16_bf16 v[160:175], v[148:151], v[228:231], v[160:175]
    v_mul_f32 v195, v195, v178
    v_mul_f32 v196, v196, v181
    v_mul_f32 v197, v197, v180
    v_mfma_f32_32x32x16_bf16 v[160:175], v[152:155], v[232:235], v[160:175]
    v_mul_f32 v198, v198, v183
    v_mul_f32 v199, v199, v182
    v_cvt_pk_bf16_f32 v192, v192, v193
    v_mfma_f32_32x32x16_bf16 v[160:175], v[156:159], v[236:239], v[160:175]
    v_cvt_pk_bf16_f32 v193, v194, v195
    v_cvt_pk_bf16_f32 v194, v196, v197
    v_cvt_pk_bf16_f32 v195, v198, v199
    s_nop 1
    v_mfma_f32_32x32x16_bf16 v[0:15], v[216:219], v[192:195], v[0:15]
    s_cbranch_vccnz F__opt1
    v_mul_f32 v200, v200, v185
    v_mul_f32 v201, v201, v184
    v_mul_f32 v202, v202, v187
    v_mul_f32 v203, v203, v186
    v_mul_f32 v204, v204, v189
    v_mul_f32 v205, v205, v188
    v_mul_f32 v206, v206, v191
    v_mul_f32 v207, v207, v190
    v_cvt_pk_bf16_f32 v196, v200, v201
    v_cvt_pk_bf16_f32 v197, v202, v203
    v_cvt_pk_bf16_f32 v198, v204, v205
    v_cvt_pk_bf16_f32 v199, v206, v207
    s_nop 1
    v_mfma_f32_32x32x16_bf16 v[0:15], v[220:223], v[196:199], v[0:15]
F__opt1:
    s_waitcnt lgkmcnt(0)
    v_mfma_f32_32x32x8_bf16 v[176:191], v[242:243], v[240:241], 0
    ds_read_b128 v[224:227], v247 offset:16384
    ds_read_b128 v[228:231], v247 offset:17408
    ds_read_b128 v[232:235], v247 offset:18432
    ds_read_b128 v[236:239], v247 offset:19456
    ds_read_b64 v[240:241], v247 offset:28672
    s_add_u32 m0, s27, 4096
    s_nop 0
    buffer_load_dwordx4 v128, s[4:7], s88 offen offset:0 lds
    buffer_load_dwordx4 v129, s[4:7], s89 offen offset:1024 lds
    buffer_load_dwordx4 v130, s[4:7], s90 offen offset:2048 lds
    buffer_load_dwordx4 v131, s[4:7], s91 offen offset:3072 lds
    s_waitcnt lgkmcnt(1)
    v_mfma_f32_32x32x16_bf16 v[192:207], v[144:147], v[224:227], 0
    v_mul_f32 v160, v160, v177
    v_mul_f32 v161, v161, v176
    v_mul_f32 v162, v162, v179
    v_mfma_f32_32x32x16_bf16 v[192:207], v[148:151], v[228:231], v[192:207]
    v_mul_f32 v163, v163, v178
    v_mul_f32 v164, v164, v181
    v_mul_f32 v165, v165, v180
    v_mfma_f32_32x32x16_bf16 v[192:207], v[152:155], v[232:235], v[192:207]
    v_mul_f32 v166, v166, v183
    v_mul_f32 v167, v167, v182
    v_cvt_pk_bf16_f32 v160, v160, v161
    v_mfma_f32_32x32x16_bf16 v[192:207], v[156:159], v[236:239], v[192:207]
    v_cvt_pk_bf16_f32 v161, v162, v163
    v_cvt_pk_bf16_f32 v162, v164, v165
    v_cvt_pk_bf16_f32 v163, v166, v167
    s_nop 1
    v_mfma_f32_32x32x16_bf16 v[16:31], v[216:219], v[160:163], v[16:31]
    s_cbranch_vccnz F__opt2
    v_mul_f32 v168, v168, v185
    v_mul_f32 v169, v169, v184
    v_mul_f32 v170, v170, v187
    v_mul_f32 v171, v171, v186
    v_mul_f32 v172, v172, v189
    v_mul_f32 v173, v173, v188
    v_mul_f32 v174, v174, v191
    v_mul_f32 v175, v175, v190
    v_cvt_pk_bf16_f32 v164, v168, v169
    v_cvt_pk_bf16_f32 v165, v170, v171
    v_cvt_pk_bf16_f32 v166, v172, v173
    v_cvt_pk_bf16_f32 v167, v174, v175
    s_nop 1
    v_mfma_f32_32x32x16_bf16 v[16:31], v[220:223], v[164:167], v[16:31]
F__opt2:
    s_waitcnt lgkmcnt(0)
    v_mfma_f32_32x32x8_bf16 v[176:191], v[242:243], v[240:241], 0
    ds_read_b128 v[224:227], v247 offset:20480
    ds_read_b128 v[228:231], v247 offset:21504
    ds_read_b128 v[232:235], v247 offset:22528
    ds_read_b128 v[236:239], v247 offset:23552
    ds_read_b64 v[240:241], v247 offset:29696
    s_add_u32 m0, s27, 8192
    s_nop 0
    buffer_load_dwordx4 v128, s[4:7], s92 offen offset:0 lds
    buffer_load_dwordx4 v129, s[4:7], s93 offen offset:1024 lds
    buffer_load_dwordx4 v130, s[4:7], s94 offen offset:2048 lds
    buffer_load_dwordx4 v131, s[4:7], s95 offen offset:3072 lds
    s_waitcnt lgkmcnt(1)
    v_mfma_f32_32x32x16_bf16 v[160:175], v[144:147], v[224:227], 0
    v_mul_f32 v192, v192, v177
    v_mul_f32 v193, v193, v176
    v_mul_f32 v194, v194, v179
    v_mfma_f32_32x32x16_bf16 v[160:175], v[148:151], v[228:231], v[160:175]
    v_mul_f32 v195, v195, v178
    v_mul_f32 v196, v196, v181
    v_mul_f32 v197, v197, v180
    v_mfma_f32_32x32x16_bf16 v[160:175], v[152:155], v[232:235], v[160:175]
    v_mul_f32 v198, v198, v183
    v_mul_f32 v199, v199, v182
    v_cvt_pk_bf16_f32 v192, v192, v193
    v_mfma_f32_32x32x16_bf16 v[160:175], v[156:159], v[236:239], v[160:175]
    v_cvt_pk_bf16_f32 v193, v194, v195
    v_cvt_pk_bf16_f32 v194, v196, v197
    v_cvt_pk_bf16_f32 v195, v198, v199
    s_cbranch_vccnz F__opt3
    v_mul_f32 v200, v200, v185
    v_mul_f32 v201, v201, v184
    v_mul_f32 v202, v202, v187
    v_mul_f32 v203, v203, v186
    v_mul_f32 v204, v204, v189
    v_mul_f32 v205, v205, v188
    v_mul_f32 v206, v206, v191
    v_mul_f32 v207, v207, v190
    v_cvt_pk_bf16_f32 v196, v200, v201
    v_cvt_pk_bf16_f32 v197, v202, v203
    v_cvt_pk_bf16_f32 v198, v204, v205
    v_cvt_pk_bf16_f32 v199, v206, v207
F__opt3:
    s_waitcnt lgkmcnt(0)
    v_mfma_f32_32x32x8_bf16 v[176:191], v[242:243], v[240:241], 0
    ds_write_b16_d16_hi v251, v208
    ds_read_b128 v[224:227], v211
    ds_read_b128 v[228:231], v250
    ds_write_b16 v251, v209
    ds_read_b128 v[232:235], v211
    ds_read_b128 v[236:239], v250
    ds_write_b16_d16_hi v251, v209
    ds_read_b128 v[200:203], v211
    ds_read_b128 v[204:207], v250
    ds_write_b16 v251, v241
    s_nop 1
    v_mul_f32 v160, v160, v177
    v_mul_f32 v161, v161, v176
    v_mul_f32 v162, v162, v179
    s_waitcnt lgkmcnt(2)
    v_mfma_f32_32x32x16_bf16 v[32:47], v[224:227], v[192:195], v[32:47]
    v_mul_f32 v163, v163, v178
    v_mul_f32 v164, v164, v181
    v_mul_f32 v165, v165, v180
    v_mfma_f32_32x32x16_bf16 v[64:79], v[232:235], v[192:195], v[64:79]
    v_mul_f32 v166, v166, v183
    v_mul_f32 v167, v167, v182
    v_cvt_pk_bf16_f32 v160, v160, v161
    v_mfma_f32_32x32x16_bf16 v[96:111], v[200:203], v[192:195], v[96:111]
    v_cvt_pk_bf16_f32 v161, v162, v163
    v_cvt_pk_bf16_f32 v162, v164, v165
    v_cvt_pk_bf16_f32 v163, v166, v167
    s_nop 0
    s_cbranch_vccnz F__opt4
    v_mfma_f32_32x32x16_bf16 v[32:47], v[228:231], v[196:199], v[32:47]
    v_mul_f32 v168, v168, v185
    v_mul_f32 v169, v169, v184
    v_mul_f32 v170, v170, v187
    v_mul_f32 v171, v171, v186
    v_mfma_f32_32x32x16_bf16 v[64:79], v[236:239], v[196:199], v[64:79]
    v_mul_f32 v172, v172, v189
    v_mul_f32 v173, v173, v188
    v_mul_f32 v174, v174, v191
    v_mul_f32 v175, v175, v190
    s_waitcnt lgkmcnt(1)
    v_mfma_f32_32x32x16_bf16 v[96:111], v[204:207], v[196:199], v[96:111]
    v_cvt_pk_bf16_f32 v164, v168, v169
    v_cvt_pk_bf16_f32 v165, v170, v171
    v_cvt_pk_bf16_f32 v166, v172, v173
    v_cvt_pk_bf16_f32 v167, v174, v175
    s_nop 1
    v_mfma_f32_32x32x16_bf16 v[48:63], v[228:231], v[164:167], v[48:63]
    v_mfma_f32_32x32x16_bf16 v[80:95], v[236:239], v[164:167], v[80:95]
    v_mfma_f32_32x32x16_bf16 v[112:127], v[204:207], v[164:167], v[112:127]
F__opt4:
    v_mfma_f32_32x32x16_bf16 v[48:63], v[224:227], v[160:163], v[48:63]
    v_mfma_f32_32x32x16_bf16 v[80:95], v[232:235], v[160:163], v[80:95]
    ds_read_b128 v[224:227], v247 offset:8192
    ds_read_b128 v[228:231], v247 offset:9216
    ds_read_b128 v[232:235], v247 offset:10240
    ds_read_b128 v[236:239], v247 offset:11264
    ds_read_b64 v[240:241], v247 offset:26624
    v_mfma_f32_32x32x16_bf16 v[112:127], v[200:203], v[160:163], v[112:127]
    s_add_u32 s28, s28, 128
    s_waitcnt vmcnt(8)
    ds_read_u16_d16_hi v161, v255 offset:0
    ds_read_u16_d16_hi v160, v255 offset:1024
    ds_read_u16_d16_hi v163, v255 offset:2048
    ds_read_u16_d16_hi v162, v255 offset:3072
    ds_read_u16_d16_hi v165, v255 offset:256
    ds_read_u16_d16_hi v164, v255 offset:1280
    ds_read_u16_d16_hi v167, v255 offset:2304
    ds_read_u16_d16_hi v166, v255 offset:3328
    s_waitcnt lgkmcnt(8)
    v_mfma_f32_32x32x8_bf16 v[192:207], v[242:243], v[240:241], 0
    v_mfma_f32_32x32x16_bf16 v[176:191], v[144:147], v[224:227], 0
    v_mfma_f32_32x32x16_bf16 v[176:191], v[148:151], v[228:231], v[176:191]
    s_cbranch_vccnz F__opt5
    ds_read_u16_d16_hi v169, v255 offset:512
    ds_read_u16_d16_hi v168, v255 offset:1536
    ds_read_u16_d16_hi v171, v255 offset:2560
    ds_read_u16_d16_hi v170, v255 offset:3584
    ds_read_u16_d16_hi v173, v255 offset:768
    ds_read_u16_d16_hi v172, v255 offset:1792
    ds_read_u16_d16_hi v175, v255 offset:2816
    ds_read_u16_d16_hi v174, v255 offset:3840
F__opt5:
    v_mfma_f32_32x32x16_bf16 v[176:191], v[152:155], v[232:235], v[176:191]
    v_mfma_f32_32x32x16_bf16 v[176:191], v[156:159], v[236:239], v[176:191]
    ds_read_b128 v[224:227], v247 offset:12288
    ds_read_b128 v[228:231], v247 offset:13312
    ds_read_b128 v[232:235], v247 offset:14336
    ds_read_b128 v[236:239], v247 offset:15360
    ds_read_b64 v[240:241], v247 offset:27648
    v_mad_u32_u16 v140, v140, s38, v243
    v_mad_u32_u16 v141, v141, s38, v243
    v_mad_u32_u16 v142, v142, s38, v243
    v_mad_u32_u16 v143, v143, s38, v243
    buffer_load_dwordx4 v[128:131], v140, s[76:79], 0 offen sc1
    buffer_load_dwordx4 v[132:135], v141, s[76:79], 0 offen sc1
    buffer_load_dwordx4 v[136:139], v142, s[76:79], 0 offen sc1
    buffer_load_dwordx4 v[140:143], v143, s[76:79], 0 offen sc1
    v_mul_f32 v176, v176, v193
    v_mul_f32 v177, v177, v192
    v_mul_f32 v178, v178, v195
    v_mul_f32 v179, v179, v194
    v_mul_f32 v180, v180, v197
    v_mul_f32 v181, v181, v196
    v_mul_f32 v182, v182, v199
    v_mul_f32 v183, v183, v198
    s_cbranch_vccnz F__opt6
    v_mul_f32 v184, v184, v201
    v_mul_f32 v185, v185, v200
    v_mul_f32 v186, v186, v203
    v_mul_f32 v187, v187, v202
    v_mul_f32 v188, v188, v205
    v_mul_f32 v189, v189, v204
    v_mul_f32 v190, v190, v207
    v_mul_f32 v191, v191, v206
F__opt6:
    s_waitcnt vmcnt(8)
    ds_read_u16_d16_hi v193, v255 offset:4096
    ds_read_u16_d16_hi v192, v255 offset:5120
    ds_read_u16_d16_hi v195, v255 offset:6144
    ds_read_u16_d16_hi v194, v255 offset:7168
    ds_read_u16_d16_hi v197, v255 offset:4352
    ds_read_u16_d16_hi v196, v255 offset:5376
    ds_read_u16_d16_hi v199, v255 offset:6400
    ds_read_u16_d16_hi v198, v255 offset:7424
    s_waitcnt lgkmcnt(13)
    v_mul_f32 v161, v161, v176
    v_mul_f32 v160, v160, v177
    v_mul_f32 v163, v163, v178
    v_mul_f32 v162, v162, v179
    v_mul_f32 v165, v165, v180
    v_mul_f32 v164, v164, v181
    v_mul_f32 v167, v167, v182
    v_mul_f32 v166, v166, v183
    v_cvt_pk_bf16_f32 v160, v161, v160
    v_cvt_pk_bf16_f32 v161, v163, v162
    v_cvt_pk_bf16_f32 v162, v165, v164
    v_cvt_pk_bf16_f32 v163, v167, v166
    s_nop 1
    v_mfma_f32_32x32x16_bf16 v[32:47], v[216:219], v[160:163], v[32:47]
    s_cbranch_vccnz F__opt7
    ds_read_u16_d16_hi v201, v255 offset:4608
    ds_read_u16_d16_hi v200, v255 offset:5632
    ds_read_u16_d16_hi v203, v255 offset:6656
    ds_read_u16_d16_hi v202, v255 offset:7680
    ds_read_u16_d16_hi v205, v255 offset:4864
    ds_read_u16_d16_hi v204, v255 offset:5888
    ds_read_u16_d16_hi v207, v255 offset:6912
    ds_read_u16_d16_hi v206, v255 offset:7936
    v_mul_f32 v169, v169, v184
    v_mul_f32 v168, v168, v185
    v_mul_f32 v171, v171, v186
    v_mul_f32 v170, v170, v187
    v_mul_f32 v173, v173, v188
    v_mul_f32 v172, v172, v189
    v_mul_f32 v175, v175, v190
    v_mul_f32 v174, v174, v191
    v_cvt_pk_bf16_f32 v164, v169, v168
    v_cvt_pk_bf16_f32 v165, v171, v170
    v_cvt_pk_bf16_f32 v166, v173, v172
    v_cvt_pk_bf16_f32 v167, v175, v174
    s_nop 1
    v_mfma_f32_32x32x16_bf16 v[32:47], v[220:223], v[164:167], v[32:47]
F__opt7:
    s_waitcnt vmcnt(4)
    ds_read_u16_d16_hi v161, v255 offset:8192
    ds_read_u16_d16_hi v160, v255 offset:9216
    ds_read_u16_d16_hi v163, v255 offset:10240
    ds_read_u16_d16_hi v162, v255 offset:11264
    ds_read_u16_d16_hi v165, v255 offset:8448
    ds_read_u16_d16_hi v164, v255 offset:9472
    ds_read_u16_d16_hi v167, v255 offset:10496
    ds_read_u16_d16_hi v166, v255 offset:11520
    s_waitcnt lgkmcnt(8)
    v_mul_f32 v193, v193, v176
    v_mul_f32 v192, v192, v177
    v_mul_f32 v195, v195, v178
    v_mul_f32 v194, v194, v179
    v_mul_f32 v197, v197, v180
    v_mul_f32 v196, v196, v181
    v_mul_f32 v199, v199, v182
    v_mul_f32 v198, v198, v183
    v_cvt_pk_bf16_f32 v192, v193, v192
    v_cvt_pk_bf16_f32 v193, v195, v194
    v_cvt_pk_bf16_f32 v194, v197, v196
    v_cvt_pk_bf16_f32 v195, v199, v198
    s_nop 1
    v_mfma_f32_32x32x16_bf16 v[64:79], v[216:219], v[192:195], v[64:79]
    s_cbranch_vccnz F__opt8
    ds_read_u16_d16_hi v169, v255 offset:8704
    ds_read_u16_d16_hi v168, v255 offset:9728
    ds_read_u16_d16_hi v171, v255 offset:10752
    ds_read_u16_d16_hi v170, v255 offset:11776
    ds_read_u16_d16_hi v173, v255 offset:8960
    ds_read_u16_d16_hi v172, v255 offset:9984
    ds_read_u16_d16_hi v175, v255 offset:11008
    ds_read_u16_d16_hi v174, v255 offset:12032
    v_mul_f32 v201, v201, v184
    v_mul_f32 v200, v200, v185
    v_mul_f32 v203, v203, v186
    v_mul_f32 v202, v202, v187
    v_mul_f32 v205, v205, v188
    v_mul_f32 v204, v204, v189
    v_mul_f32 v207, v207, v190
    v_mul_f32 v206, v206, v191
    v_cvt_pk_bf16_f32 v196, v201, v200
    v_cvt_pk_bf16_f32 v197, v203, v202
    v_cvt_pk_bf16_f32 v198, v205, v204
    v_cvt_pk_bf16_f32 v199, v207, v206
    s_nop 1
    v_mfma_f32_32x32x16_bf16 v[64:79], v[220:223], v[196:199], v[64:79]
F__opt8:
    v_mfma_f32_32x32x16_bf16 v[192:207], v[144:147], v[224:227], 0
    s_waitcnt lgkmcnt(0)
    v_mul_f32 v161, v161, v176
    v_mul_f32 v160, v160, v177
    v_mul_f32 v163, v163, v178
    v_mfma_f32_32x32x16_bf16 v[192:207], v[148:151], v[228:231], v[192:207]
    v_mul_f32 v162, v162, v179
    v_mul_f32 v165, v165, v180
    v_mul_f32 v164, v164, v181
    v_mfma_f32_32x32x16_bf16 v[192:207], v[152:155], v[232:235], v[192:207]
    v_mul_f32 v167, v167, v182
    v_mul_f32 v166, v166, v183
    v_cvt_pk_bf16_f32 v160, v161, v160
    v_mfma_f32_32x32x16_bf16 v[192:207], v[156:159], v[236:239], v[192:207]
    v_cvt_pk_bf16_f32 v161, v163, v162
    v_cvt_pk_bf16_f32 v162, v165, v164
    v_cvt_pk_bf16_f32 v163, v167, v166
    s_nop 1
    v_mfma_f32_32x32x16_bf16 v[96:111], v[216:219], v[160:163], v[96:111]
    s_cbranch_vccnz F__opt9
    v_mul_f32 v169, v169, v184
    v_mul_f32 v168, v168, v185
    v_mul_f32 v171, v171, v186
    v_mul_f32 v170, v170, v187
    v_mul_f32 v173, v173, v188
    v_mul_f32 v172, v172, v189
    v_mul_f32 v175, v175, v190
    v_mul_f32 v174, v174, v191
    v_cvt_pk_bf16_f32 v164, v169, v168
    v_cvt_pk_bf16_f32 v165, v171, v170
    v_cvt_pk_bf16_f32 v166, v173, v172
    v_cvt_pk_bf16_f32 v167, v175, v174
    s_nop 1
    v_mfma_f32_32x32x16_bf16 v[96:111], v[220:223], v[164:167], v[96:111]
F__opt9:
    v_mfma_f32_32x32x8_bf16 v[176:191], v[242:243], v[240:241], 0
    ds_read_u16_d16_hi v161, v255 offset:2
    ds_read_u16_d16_hi v160, v255 offset:1026
    ds_read_u16_d16_hi v163, v255 offset:2050
    ds_read_u16_d16_hi v162, v255 offset:3074
    ds_read_u16_d16_hi v165, v255 offset:258
    ds_read_u16_d16_hi v164, v255 offset:1282
    ds_read_u16_d16_hi v167, v255 offset:2306
    ds_read_u16_d16_hi v166, v255 offset:3330
    s_cbranch_vccnz F__opt10
    ds_read_u16_d16_hi v169, v255 offset:514
    ds_read_u16_d16_hi v168, v255 offset:1538
    ds_read_u16_d16_hi v171, v255 offset:2562
    ds_read_u16_d16_hi v170, v255 offset:3586
    ds_read_u16_d16_hi v173, v255 offset:770
    ds_read_u16_d16_hi v172, v255 offset:1794
    ds_read_u16_d16_hi v175, v255 offset:2818
    ds_read_u16_d16_hi v174, v255 offset:3842
F__opt10:
    s_cmp_lg_u32 s67, 1
    s_cbranch_scc1 F__neu1
    v_cvt_pk_bf16_f32 v0, v0, v16
    buffer_store_dword v0, v254, s[20:23], s34 offen offset:0 sc1
    v_cvt_pk_bf16_f32 v1, v1, v17
    buffer_store_dword v1, v254, s[20:23], s34 offen offset:512 sc1
    v_cvt_pk_bf16_f32 v2, v2, v18
    buffer_store_dword v2, v254, s[20:23], s34 offen offset:1024 sc1
    v_cvt_pk_bf16_f32 v3, v3, v19
    buffer_store_dword v3, v254, s[20:23], s34 offen offset:1536 sc1
    v_cvt_pk_bf16_f32 v4, v4, v20
    buffer_store_dword v4, v254, s[20:23], s35 offen offset:0 sc1
    v_cvt_pk_bf16_f32 v5, v5, v21
    buffer_store_dword v5, v254, s[20:23], s35 offen offset:512 sc1
    v_cvt_pk_bf16_f32 v6, v6, v22
    buffer_store_dword v6, v254, s[20:23], s35 offen offset:1024 sc1
    v_cvt_pk_bf16_f32 v7, v7, v23
    buffer_store_dword v7, v254, s[20:23], s35 offen offset:1536 sc1
    v_cvt_pk_bf16_f32 v8, v8, v24
    buffer_store_dword v8, v254, s[20:23], s36 offen offset:0 sc1
    v_cvt_pk_bf16_f32 v9, v9, v25
    buffer_store_dword v9, v254, s[20:23], s36 offen offset:512 sc1
    v_cvt_pk_bf16_f32 v10, v10, v26
    buffer_store_dword v10, v254, s[20:23], s36 offen offset:1024 sc1
    v_cvt_pk_bf16_f32 v11, v11, v27
    buffer_store_dword v11, v254, s[20:23], s36 offen offset:1536 sc1
    s_mov_b64 exec, s[64:65]
    v_cvt_pk_bf16_f32 v12, v12, v28
    buffer_store_dword v12, v254, s[20:23], s37 offen offset:0 sc1
    s_mov_b64 exec, -1
F__neu1:
    s_nop 0
    v_mul_f32 v192, v192, v177
    v_mul_f32 v193, v193, v176
    v_mul_f32 v194, v194, v179
    v_mul_f32 v195, v195, v178
    v_mul_f32 v196, v196, v181
    v_mul_f32 v197, v197, v180
    v_mul_f32 v198, v198, v183
    v_mul_f32 v199, v199, v182
    s_cbranch_vccnz F__opt11
    v_mul_f32 v200, v200, v185
    v_mul_f32 v201, v201, v184
    v_mul_f32 v202, v202, v187
    v_mul_f32 v203, v203, v186
    v_mul_f32 v204, v204, v189
    v_mul_f32 v205, v205, v188
    v_mul_f32 v206, v206, v191
    v_mul_f32 v207, v207, v190
F__opt11:
    ds_read_u16_d16_hi v177, v255 offset:4098
    ds_read_u16_d16_hi v176, v255 offset:5122
    ds_read_u16_d16_hi v179, v255 offset:6146
    ds_read_u16_d16_hi v178, v255 offset:7170
    ds_read_u16_d16_hi v181, v255 offset:4354
    ds_read_u16_d16_hi v180, v255 offset:5378
    ds_read_u16_d16_hi v183, v255 offset:6402
    ds_read_u16_d16_hi v182, v255 offset:7426
    s_waitcnt lgkmcnt(8)
    v_mul_f32 v161, v161, v192
    v_mul_f32 v160, v160, v193
    v_mul_f32 v163, v163, v194
    v_mul_f32 v162, v162, v195
    v_mul_f32 v165, v165, v196
    v_mul_f32 v164, v164, v197
    v_mul_f32 v167, v167, v198
    v_mul_f32 v166, v166, v199
    v_cvt_pk_bf16_f32 v160, v161, v160
    v_cvt_pk_bf16_f32 v161, v163, v162
    v_cvt_pk_bf16_f32 v162, v165, v164
    v_cvt_pk_bf16_f32 v163, v167, v166
    s_nop 1
    v_mfma_f32_32x32x16_bf16 v[48:63], v[216:219], v[160:163], v[48:63]
    s_cbranch_vccnz F__opt12
    ds_read_u16_d16_hi v185, v255 offset:4610
    ds_read_u16_d16_hi v184, v255 offset:5634
    ds_read_u16_d16_hi v187, v255 offset:6658
    ds_read_u16_d16_hi v186, v255 offset:7682
    ds_read_u16_d16_hi v189, v255 offset:4866
    ds_read_u16_d16_hi v188, v255 offset:5890
    ds_read_u16_d16_hi v191, v255 offset:6914
    ds_read_u16_d16_hi v190, v255 offset:7938
    v_mul_f32 v169, v169, v200
    v_mul_f32 v168, v168, v201
    v_mul_f32 v171, v171, v202
    v_mul_f32 v170, v170, v203
    v_mul_f32 v173, v173, v204
    v_mul_f32 v172, v172, v205
    v_mul_f32 v175, v175, v206
    v_mul_f32 v174, v174, v207
    v_cvt_pk_bf16_f32 v164, v169, v168
    v_cvt_pk_bf16_f32 v165, v171, v170
    v_cvt_pk_bf16_f32 v166, v173, v172
    v_cvt_pk_bf16_f32 v167, v175, v174
    s_nop 1
    v_mfma_f32_32x32x16_bf16 v[48:63], v[220:223], v[164:167], v[48:63]
F__opt12:
    ds_read_u16_d16_hi v161, v255 offset:8194
    ds_read_u16_d16_hi v160, v255 offset:9218
    ds_read_u16_d16_hi v163, v255 offset:10242
    ds_read_u16_d16_hi v162, v255 offset:11266
    ds_read_u16_d16_hi v165, v255 offset:8450
    ds_read_u16_d16_hi v164, v255 offset:9474
    ds_read_u16_d16_hi v167, v255 offset:10498
    ds_read_u16_d16_hi v166, v255 offset:11522
    s_waitcnt lgkmcnt(8)
    v_mul_f32 v177, v177, v192
    v_mul_f32 v176, v176, v193
    v_mul_f32 v179, v179, v194
    v_mul_f32 v178, v178, v195
    v_mul_f32 v181, v181, v196
    v_mul_f32 v180, v180, v197
    v_mul_f32 v183, v183, v198
    v_mul_f32 v182, v182, v199
    v_cvt_pk_bf16_f32 v176, v177, v176
    v_cvt_pk_bf16_f32 v177, v179, v178
    v_cvt_pk_bf16_f32 v178, v181, v180
    v_cvt_pk_bf16_f32 v179, v183, v182
    s_nop 1
    v_mfma_f32_32x32x16_bf16 v[80:95], v[216:219], v[176:179], v[80:95]
    s_cbranch_vccnz F__opt13
    ds_read_u16_d16_hi v169, v255 offset:8706
    ds_read_u16_d16_hi v168, v255 offset:9730
    ds_read_u16_d16_hi v171, v255 offset:10754
    ds_read_u16_d16_hi v170, v255 offset:11778
    ds_read_u16_d16_hi v173, v255 offset:8962
    ds_read_u16_d16_hi v172, v255 offset:9986
    ds_read_u16_d16_hi v175, v255 offset:11010
    ds_read_u16_d16_hi v174, v255 offset:12034
    v_mul_f32 v185, v185, v200
    v_mul_f32 v184, v184, v201
    v_mul_f32 v187, v187, v202
    v_mul_f32 v186, v186, v203
    v_mul_f32 v189, v189, v204
    v_mul_f32 v188, v188, v205
    v_mul_f32 v191, v191, v206
    v_mul_f32 v190, v190, v207
    v_cvt_pk_bf16_f32 v180, v185, v184
    v_cvt_pk_bf16_f32 v181, v187, v186
    v_cvt_pk_bf16_f32 v182, v189, v188
    v_cvt_pk_bf16_f32 v183, v191, v190
    s_nop 1
    v_mfma_f32_32x32x16_bf16 v[80:95], v[220:223], v[180:183], v[80:95]
F__opt13:
    s_cmp_lg_u32 s67, 1
    s_cbranch_scc1 F__neu2
    v_cvt_pk_bf16_f32 v32, v32, v48
    buffer_store_dword v32, v254, s[20:23], s34 offen offset:128 sc1
    v_cvt_pk_bf16_f32 v33, v33, v49
    buffer_store_dword v33, v254, s[20:23], s34 offen offset:640 sc1
    v_cvt_pk_bf16_f32 v34, v34, v50
    buffer_store_dword v34, v254, s[20:23], s34 offen offset:1152 sc1
    v_cvt_pk_bf16_f32 v35, v35, v51
    buffer_store_dword v35, v254, s[20:23], s34 offen offset:1664 sc1
    v_cvt_pk_bf16_f32 v36, v36, v52
    buffer_store_dword v36, v254, s[20:23], s35 offen offset:128 sc1
    v_cvt_pk_bf16_f32 v37, v37, v53
    buffer_store_dword v37, v254, s[20:23], s35 offen offset:640 sc1
    v_cvt_pk_bf16_f32 v38, v38, v54
    buffer_store_dword v38, v254, s[20:23], s35 offen offset:1152 sc1
    v_cvt_pk_bf16_f32 v39, v39, v55
    buffer_store_dword v39, v254, s[20:23], s35 offen offset:1664 sc1
    v_cvt_pk_bf16_f32 v40, v40, v56
    buffer_store_dword v40, v254, s[20:23], s36 offen offset:128 sc1
    v_cvt_pk_bf16_f32 v41, v41, v57
    buffer_store_dword v41, v254, s[20:23], s36 offen offset:640 sc1
    v_cvt_pk_bf16_f32 v42, v42, v58
    buffer_store_dword v42, v254, s[20:23], s36 offen offset:1152 sc1
    v_cvt_pk_bf16_f32 v43, v43, v59
    buffer_store_dword v43, v254, s[20:23], s36 offen offset:1664 sc1
    s_mov_b64 exec, s[64:65]
    v_cvt_pk_bf16_f32 v44, v44, v60
    buffer_store_dword v44, v254, s[20:23], s37 offen offset:128 sc1
    s_mov_b64 exec, -1
F__neu2:
    s_waitcnt lgkmcnt(0)
    v_mul_f32 v161, v161, v192
    v_mul_f32 v160, v160, v193
    v_mul_f32 v163, v163, v194
    v_mul_f32 v162, v162, v195
    v_mul_f32 v165, v165, v196
    v_mul_f32 v164, v164, v197
    v_mul_f32 v167, v167, v198
    v_mul_f32 v166, v166, v199
    v_cvt_pk_bf16_f32 v160, v161, v160
    v_cvt_pk_bf16_f32 v161, v163, v162
    v_cvt_pk_bf16_f32 v162, v165, v164
    v_cvt_pk_bf16_f32 v163, v167, v166
    s_nop 1
    v_mfma_f32_32x32x16_bf16 v[112:127], v[216:219], v[160:163], v[112:127]
    s_cbranch_vccnz F__opt14
    v_mul_f32 v169, v169, v200
    v_mul_f32 v168, v168, v201
    v_mul_f32 v171, v171, v202
    v_mul_f32 v170, v170, v203
    v_mul_f32 v173, v173, v204
    v_mul_f32 v172, v172, v205
    v_mul_f32 v175, v175, v206
    v_mul_f32 v174, v174, v207
    v_cvt_pk_bf16_f32 v164, v169, v168
    v_cvt_pk_bf16_f32 v165, v171, v170
    v_cvt_pk_bf16_f32 v166, v173, v172
    v_cvt_pk_bf16_f32 v167, v175, v174
    s_nop 1
    v_mfma_f32_32x32x16_bf16 v[112:127], v[220:223], v[164:167], v[112:127]
F__opt14:
    s_cmp_lg_u32 s67, 1
    s_cbranch_scc1 F__neu3
    v_cvt_pk_bf16_f32 v64, v64, v80
    buffer_store_dword v64, v254, s[20:23], s34 offen offset:256 sc1
    v_cvt_pk_bf16_f32 v65, v65, v81
    buffer_store_dword v65, v254, s[20:23], s34 offen offset:768 sc1
    v_cvt_pk_bf16_f32 v66, v66, v82
    buffer_store_dword v66, v254, s[20:23], s34 offen offset:1280 sc1
    v_cvt_pk_bf16_f32 v67, v67, v83
    buffer_store_dword v67, v254, s[20:23], s34 offen offset:1792 sc1
    v_cvt_pk_bf16_f32 v68, v68, v84
    buffer_store_dword v68, v254, s[20:23], s35 offen offset:256 sc1
    v_cvt_pk_bf16_f32 v69, v69, v85
    buffer_store_dword v69, v254, s[20:23], s35 offen offset:768 sc1
    v_cvt_pk_bf16_f32 v70, v70, v86
    buffer_store_dword v70, v254, s[20:23], s35 offen offset:1280 sc1
    v_cvt_pk_bf16_f32 v71, v71, v87
    buffer_store_dword v71, v254, s[20:23], s35 offen offset:1792 sc1
    v_cvt_pk_bf16_f32 v72, v72, v88
    buffer_store_dword v72, v254, s[20:23], s36 offen offset:256 sc1
    v_cvt_pk_bf16_f32 v73, v73, v89
    buffer_store_dword v73, v254, s[20:23], s36 offen offset:768 sc1
    v_cvt_pk_bf16_f32 v74, v74, v90
    buffer_store_dword v74, v254, s[20:23], s36 offen offset:1280 sc1
    v_cvt_pk_bf16_f32 v75, v75, v91
    buffer_store_dword v75, v254, s[20:23], s36 offen offset:1792 sc1
    s_mov_b64 exec, s[64:65]
    v_cvt_pk_bf16_f32 v76, v76, v92
    buffer_store_dword v76, v254, s[20:23], s37 offen offset:256 sc1
    s_mov_b64 exec, -1
F__neu3:
    s_sub_u32 s30, s30, 1
    s_cmp_lg_u32 s30, 0
    s_cbranch_scc1 F_loop
F_last:
F_tiles_done:
    s_cmp_lt_u32 s31, s32
    s_cbranch_scc1 F_round
    s_setprio 3
    v_lshl_add_u32 v246, v249, 7, v248
    s_cmp_eq_u32 s67, 1
    s_cbranch_scc1 F_st3
    v_cvt_pk_bf16_f32 v0, v0, v16
    buffer_store_dword v0, v254, s[20:23], s34 offen offset:0 sc1
    v_cvt_pk_bf16_f32 v1, v1, v17
    buffer_store_dword v1, v254, s[20:23], s34 offen offset:512 sc1
    v_cvt_pk_bf16_f32 v2, v2, v18
    buffer_store_dword v2, v254, s[20:23], s34 offen offset:1024 sc1
    v_cvt_pk_bf16_f32 v3, v3, v19
    buffer_store_dword v3, v254, s[20:23], s34 offen offset:1536 sc1
    v_cvt_pk_bf16_f32 v4, v4, v20
    buffer_store_dword v4, v254, s[20:23], s35 offen offset:0 sc1
    v_cvt_pk_bf16_f32 v5, v5, v21
    buffer_store_dword v5, v254, s[20:23], s35 offen offset:512 sc1
    v_cvt_pk_bf16_f32 v6, v6, v22
    buffer_store_dword v6, v254, s[20:23], s35 offen offset:1024 sc1
    v_cvt_pk_bf16_f32 v7, v7, v23
    buffer_store_dword v7, v254, s[20:23], s35 offen offset:1536 sc1
    v_cvt_pk_bf16_f32 v8, v8, v24
    buffer_store_dword v8, v254, s[20:23], s36 offen offset:0 sc1
    v_cvt_pk_bf16_f32 v9, v9, v25
    buffer_store_dword v9, v254, s[20:23], s36 offen offset:512 sc1
    v_cvt_pk_bf16_f32 v10, v10, v26
    buffer_store_dword v10, v254, s[20:23], s36 offen offset:1024 sc1
    v_cvt_pk_bf16_f32 v11, v11, v27
    buffer_store_dword v11, v254, s[20:23], s36 offen offset:1536 sc1
    s_mov_b64 exec, s[64:65]
    v_cvt_pk_bf16_f32 v12, v12, v28
    buffer_store_dword v12, v254, s[20:23], s37 offen offset:0 sc1
    s_mov_b64 exec, -1
    v_cvt_pk_bf16_f32 v32, v32, v48
    buffer_store_dword v32, v254, s[20:23], s34 offen offset:128 sc1
    v_cvt_pk_bf16_f32 v33, v33, v49
    buffer_store_dword v33, v254, s[20:23], s34 offen offset:640 sc1
    v_cvt_pk_bf16_f32 v34, v34, v50
    buffer_store_dword v34, v254, s[20:23], s34 offen offset:1152 sc1
    v_cvt_pk_bf16_f32 v35, v35, v51
    buffer_store_dword v35, v254, s[20:23], s34 offen offset:1664 sc1
    v_cvt_pk_bf16_f32 v36, v36, v52
    buffer_store_dword v36, v254, s[20:23], s35 offen offset:128 sc1
    v_cvt_pk_bf16_f32 v37, v37, v53
    buffer_store_dword v37, v254, s[20:23], s35 offen offset:640 sc1
    v_cvt_pk_bf16_f32 v38, v38, v54
    buffer_store_dword v38, v254, s[20:23], s35 offen offset:1152 sc1
    v_cvt_pk_bf16_f32 v39, v39, v55
    buffer_store_dword v39, v254, s[20:23], s35 offen offset:1664 sc1
    v_cvt_pk_bf16_f32 v40, v40, v56
    buffer_store_dword v40, v254, s[20:23], s36 offen offset:128 sc1
    v_cvt_pk_bf16_f32 v41, v41, v57
    buffer_store_dword v41, v254, s[20:23], s36 offen offset:640 sc1
    v_cvt_pk_bf16_f32 v42, v42, v58
    buffer_store_dword v42, v254, s[20:23], s36 offen offset:1152 sc1
    v_cvt_pk_bf16_f32 v43, v43, v59
    buffer_store_dword v43, v254, s[20:23], s36 offen offset:1664 sc1
    s_mov_b64 exec, s[64:65]
    v_cvt_pk_bf16_f32 v44, v44, v60
    buffer_store_dword v44, v254, s[20:23], s37 offen offset:128 sc1
    s_mov_b64 exec, -1
    v_cvt_pk_bf16_f32 v64, v64, v80
    buffer_store_dword v64, v254, s[20:23], s34 offen offset:256 sc1
    v_cvt_pk_bf16_f32 v65, v65, v81
    buffer_store_dword v65, v254, s[20:23], s34 offen offset:768 sc1
    v_cvt_pk_bf16_f32 v66, v66, v82
    buffer_store_dword v66, v254, s[20:23], s34 offen offset:1280 sc1
    v_cvt_pk_bf16_f32 v67, v67, v83
    buffer_store_dword v67, v254, s[20:23], s34 offen offset:1792 sc1
    v_cvt_pk_bf16_f32 v68, v68, v84
    buffer_store_dword v68, v254, s[20:23], s35 offen offset:256 sc1
    v_cvt_pk_bf16_f32 v69, v69, v85
    buffer_store_dword v69, v254, s[20:23], s35 offen offset:768 sc1
    v_cvt_pk_bf16_f32 v70, v70, v86
    buffer_store_dword v70, v254, s[20:23], s35 offen offset:1280 sc1
    v_cvt_pk_bf16_f32 v71, v71, v87
    buffer_store_dword v71, v254, s[20:23], s35 offen offset:1792 sc1
    v_cvt_pk_bf16_f32 v72, v72, v88
    buffer_store_dword v72, v254, s[20:23], s36 offen offset:256 sc1
    v_cvt_pk_bf16_f32 v73, v73, v89
    buffer_store_dword v73, v254, s[20:23], s36 offen offset:768 sc1
    v_cvt_pk_bf16_f32 v74, v74, v90
    buffer_store_dword v74, v254, s[20:23], s36 offen offset:1280 sc1
    v_cvt_pk_bf16_f32 v75, v75, v91
    buffer_store_dword v75, v254, s[20:23], s36 offen offset:1792 sc1
    s_mov_b64 exec, s[64:65]
    v_cvt_pk_bf16_f32 v76, v76, v92
    buffer_store_dword v76, v254, s[20:23], s37 offen offset:256 sc1
    s_mov_b64 exec, -1
F_st3:
    s_nop 0
    v_cvt_pk_bf16_f32 v96, v96, v112
    buffer_store_dword v96, v254, s[20:23], s34 offen offset:384 sc1
    v_cvt_pk_bf16_f32 v97, v97, v113
    buffer_store_dword v97, v254, s[20:23], s34 offen offset:896 sc1
    v_cvt_pk_bf16_f32 v98, v98, v114
    buffer_store_dword v98, v254, s[20:23], s34 offen offset:1408 sc1
    v_cvt_pk_bf16_f32 v99, v99, v115
    buffer_store_dword v99, v254, s[20:23], s34 offen offset:1920 sc1
    v_cvt_pk_bf16_f32 v100, v100, v116
    buffer_store_dword v100, v254, s[20:23], s35 offen offset:384 sc1
    v_cvt_pk_bf16_f32 v101, v101, v117
    buffer_store_dword v101, v254, s[20:23], s35 offen offset:896 sc1
    v_cvt_pk_bf16_f32 v102, v102, v118
    buffer_store_dword v102, v254, s[20:23], s35 offen offset:1408 sc1
    v_cvt_pk_bf16_f32 v103, v103, v119
    buffer_store_dword v103, v254, s[20:23], s35 offen offset:1920 sc1
    v_cvt_pk_bf16_f32 v104, v104, v120
    buffer_store_dword v104, v254, s[20:23], s36 offen offset:384 sc1
    v_cvt_pk_bf16_f32 v105, v105, v121
    buffer_store_dword v105, v254, s[20:23], s36 offen offset:896 sc1
    v_cvt_pk_bf16_f32 v106, v106, v122
    buffer_store_dword v106, v254, s[20:23], s36 offen offset:1408 sc1
    v_cvt_pk_bf16_f32 v107, v107, v123
    buffer_store_dword v107, v254, s[20:23], s36 offen offset:1920 sc1
    s_mov_b64 exec, s[64:65]
    v_cvt_pk_bf16_f32 v108, v108, v124
    buffer_store_dword v108, v254, s[20:23], s37 offen offset:384 sc1
    s_mov_b64 exec, -1
    s_branch F_end
F_round:
    s_waitcnt vmcnt(0) lgkmcnt(0)
    s_barrier
    s_mul_i32 s68, s26, 6
    s_and_b32 s68, s68, -4
    s_sub_u32 s49, s27, s68
    s_mov_b32 m0, s27
    v_lshrrev_b32 v200, 2, v247
    buffer_load_dword v200, s[12:15], s68 offen lds
    s_lshl_b32 s68, s25, 6
    v_lshrrev_b32 v160, 4, v247
    v_add_u32 v160, s68, v160
    v_cmp_gt_u32 vcc, 8, v160
    s_nop 0
    s_mov_b64 exec, vcc
    v_lshlrev_b32 v161, 2, v160
    v_add_u32 v161, 44032, v161
    v_mov_b32 v162, 0
    ds_write_b32 v161, v162
    s_mov_b64 exec, -1
    v_mov_b32 v176, -1
    s_cmp_ge_u32 s31, 16
    s_cbranch_scc1 F_round_ovf
    s_lshr_b32 s68, s31, 2
    s_lshl_b32 s68, s68, 7
    v_add_u32 v162, s68, v160
    v_lshrrev_b32 v164, 2, v162
    v_and_b32 v163, 3, v162
    v_lshlrev_b32 v163, 4, v163
    v_lshl_add_u32 v164, v164, 14, v163
    s_and_b32 s69, s31, 3
    s_lshl_b32 s69, s69, 2
    s_lshl_b32 s70, s24, 6
    s_add_u32 s70, s70, s69
    s_add_u32 s70, s70, 256
    v_cmp_gt_u32 vcc, 128, v160
    s_nop 0
    s_mov_b64 exec, vcc
    buffer_load_dword v176, v164, s[16:19], s70 offen sc1
    s_waitcnt vmcnt(0)
    v_bfe_u32 v163, v176, 16, 8
    v_add_u32 v164, s41, v163
    v_and_b32 v176, 0xffff, v176
    v_lshl_or_b32 v176, v164, 16, v176
    v_cmp_le_u32 vcc, 196, v163
    s_nop 0
    s_mov_b64 exec, vcc
    v_mov_b32 v176, -1
    s_mov_b64 exec, -1
    s_branch F_round_place
F_round_ovf:
    s_sub_u32 s68, s31, 16
    v_mov_b32 v163, s68
    v_lshlrev_b32 v164, 4, v160
    v_mov_b32 v165, 0
    s_mov_b32 s69, 2097408
    s_movk_i32 s70, 6250
    v_mad_u32_u24 v166, v160, s70, v163
    v_lshlrev_b32 v166, 2, v166
    v_cmp_gt_u32 vcc, 128, v160
    s_nop 0
    s_mov_b64 exec, vcc
    buffer_load_dword v165, v164, s[16:19], s69 offen sc1
    s_mov_b64 exec, -1
    s_mov_b32 s69, 2117888
    s_waitcnt vmcnt(0)
    v_and_b32 v165, 0xffffff, v165
    v_cmp_lt_u32 vcc, v163, v165
    s_nop 0
    s_mov_b64 exec, vcc
    buffer_load_dword v176, v166, s[16:19], s69 offen sc1
    s_mov_b64 exec, -1
F_round_place:
    s_add_u32 s31, s31, 1
    s_waitcnt vmcnt(0) lgkmcnt(0)
    s_barrier
    v_mov_b32 v175, 1
    s_movk_i32 s68, 2675
    s_movk_i32 s69, 196
    s_mov_b32 s70, 44032
    s_lshl_b32 s71, s41, 16
    v_lshrrev_b32 v192, 16, v176
    v_subrev_u32 v192, s41, v192
    v_cmp_gt_u32 s[52:53], s69, v192
    v_mul_u32_u24 v192, s68, v192
    v_lshrrev_b32 v192, 16, v192
    v_lshl_add_u32 v200, v192, 2, s70
    s_mov_b64 exec, s[52:53]
    ds_add_rtn_u32 v200, v200, v175
    s_mov_b64 exec, -1
    v_mov_b32 v175, 142464
    s_movk_i32 s69, 128
    s_movk_i32 s68, 2560
    v_mad_u32_u24 v192, v192, s68, v175
    s_waitcnt lgkmcnt(0)
    v_lshl_add_u32 v192, v200, 2, v192
    s_mov_b64 exec, s[52:53]
    v_cmp_gt_u32 vcc, s69, v200
    s_nop 0
    s_mov_b64 exec, vcc
    ds_write_b32 v192, v176
    s_mov_b64 exec, -1
    s_waitcnt lgkmcnt(0)
    s_barrier
    s_lshl_b32 s68, s25, 2
    s_add_u32 s68, s68, 44032
    v_mov_b32 v192, s68
    ds_read_b32 v193, v192
    s_mul_i32 s28, s25, 2560
    s_add_u32 s28, s28, 142464
    v_lshrrev_b32 v170, 4, v247
    v_lshl_add_u32 v192, v170, 2, s28
    ds_read2st64_b32 v[160:161], v192 offset0:0 offset1:1
    s_waitcnt lgkmcnt(0)
    s_branch F_prep
F_end:
    s_endpgm
.section .rodata,"a"
.p2align 6
.amdhsa_kernel gather_scatter__molecular_angular_painn__graph_kernel
  .amdhsa_next_free_vgpr 256
  .amdhsa_next_free_sgpr 98
  .amdhsa_accum_offset 256
  .amdhsa_group_segment_fixed_size 0
  .amdhsa_kernarg_size 88
  .amdhsa_user_sgpr_count 2
  .amdhsa_user_sgpr_kernarg_segment_ptr 1
  .amdhsa_system_sgpr_workgroup_id_x 1
.end_amdhsa_kernel
```
